```python
import torch

def _softmax(x, axis=-1):
    return torch.softmax(x, dim=axis)
def _gelu(x):
    return torch.nn.functional.gelu(x, approximate="tanh")
def _silu(x):
    return torch.nn.functional.silu(x)
def _sigmoid(x):
    return torch.sigmoid(x)
def _layernorm(x, axis=-1, eps=1e-5):
    m = x.mean(dim=axis, keepdim=True)
    v = x.var(dim=axis, keepdim=True, unbiased=False)
    return (x - m) / torch.sqrt(v + eps)
def _scatter_add(tgt, idx, src, axis=0):
    return tgt.clone().index_add_(axis, idx, src)
def _segment_sum(src, seg, n):
    out = torch.zeros((n,) + src.shape[1:], dtype=src.dtype)
    return out.index_add_(0, seg, src)
def _pad(x, pw):
    flat = tuple(v for pair in reversed(pw) for v in pair)
    return torch.nn.functional.pad(x, flat)

kernel_name = 'concat_heads__gqa_block_cached__mha_block_cached__near_ridge'

def setup_inputs():

    _w = (lambda a: (lambda t: t.to(torch.bfloat16) if t.is_floating_point() else t)(torch.as_tensor(a)))
    def _A_setup():
        B, Sq, D = 8, 144, 448
        Hq, Hkv, Sk, Dh = 16, 8, 1024, 256
        assert Hq % Hkv == 0, (Hq, Hkv)
        return {
            "x": _w((lambda *s: torch.randn(*s, dtype=torch.bfloat16) * 0.8)(B, Sq, D)),
            "k_cache": _w((lambda *s: torch.randn(*s, dtype=torch.bfloat16) * 0.8)(B, Hkv, Sk, Dh)),
            "v_cache": _w((lambda *s: torch.randn(*s, dtype=torch.bfloat16) * 0.05)(B, Hkv, Sk, Dh)),
            "wq": _w((lambda *s: torch.randn(*s, dtype=torch.bfloat16) * 0.8)(D, Hq * Dh) * (D ** -0.5)),
            "wo": _w((lambda *s: torch.randn(*s, dtype=torch.bfloat16) * 0.05)(Hq * Dh, D) * ((Hq * Dh) ** -0.5)),
        }
    _A_in = _A_setup()

    def _B_setup():
        B, Sq, D = 8, 144, 448
        H, Sk, Dh = 16, 1024, 256
        return {
            "x": _w((lambda *s: torch.randn(*s, dtype=torch.bfloat16) * 0.8)(B, Sq, D)),
            "k_cache": _w((lambda *s: torch.randn(*s, dtype=torch.bfloat16) * 0.8)(B, H, Sk, Dh)),
            "v_cache": _w((lambda *s: torch.randn(*s, dtype=torch.bfloat16) * 0.05)(B, H, Sk, Dh)),
            "wq": _w((lambda *s: torch.randn(*s, dtype=torch.bfloat16) * 0.8)(D, H * Dh) * (D ** -0.5)),
            "wo": _w((lambda *s: torch.randn(*s, dtype=torch.bfloat16) * 0.05)(H * Dh, D) * ((H * Dh) ** -0.5)),
        }
    _B_in = _B_setup()

    return {
        "A_x": _A_in["x"],
        "A_k_cache": _A_in["k_cache"],
        "A_v_cache": _A_in["v_cache"],
        "A_wq": _A_in["wq"],
        "A_wo": _A_in["wo"],
        "B_x": _B_in["x"],
        "B_k_cache": _B_in["k_cache"],
        "B_v_cache": _B_in["v_cache"],
        "B_wq": _B_in["wq"],
        "B_wo": _B_in["wo"],
    }

def reference(A_x, A_k_cache, A_v_cache, A_wq, A_wo, B_x, B_k_cache, B_v_cache, B_wq, B_wo):
    def _A_ref(x, k_cache, v_cache, wq, wo):
        B, Sq, D = x.shape
        Hq, Dh = 16, 256
        Hkv = k_cache.shape[1]
        rep = Hq // Hkv
        q = (lambda x, *d: x.permute(*d))((x @ wq).reshape(B, Sq, Hq, Dh), 0, 2, 1, 3)
        k = (lambda x, n, axis: torch.repeat_interleave(x, n, dim=axis))(k_cache, rep, axis=1)
        v = (lambda x, n, axis: torch.repeat_interleave(x, n, dim=axis))(v_cache, rep, axis=1)
        scores = torch.einsum("bhqd,bhkd->bhqk", q, k) * (Dh ** -0.5)
        p = _softmax(scores, axis=-1)
        o = torch.einsum("bhqk,bhkd->bhqd", p, v)
        return (lambda x, *d: x.permute(*d))(o, 0, 2, 1, 3).reshape(B, Sq, Hq * Dh) @ wo

    def _B_ref(x, k_cache, v_cache, wq, wo):
        B, Sq, D = x.shape
        H, Dh = 16, 256
        q = (lambda x, *d: x.permute(*d))((x @ wq).reshape(B, Sq, H, Dh), 0, 2, 1, 3)
        scores = torch.einsum("bhqd,bhkd->bhqk", q, k_cache) * (Dh ** -0.5)
        p = _softmax(scores, axis=-1)
        o = torch.einsum("bhqk,bhkd->bhqd", p, v_cache)
        return (lambda x, *d: x.permute(*d))(o, 0, 2, 1, 3).reshape(B, Sq, H * Dh) @ wo

    a = _A_ref(A_x, A_k_cache, A_v_cache, A_wq, A_wo)
    b = _B_ref(B_x, B_k_cache, B_v_cache, B_wq, B_wo)
    return torch.concatenate([a, b], axis=-1)
```

```asm
; @launch grid=(256,1,1) block=(256,1,1) lds=162304
.amdgcn_target "amdgcn-amd-amdhsa--gfx950"
.text
.globl concat_heads__gqa_block_cached__mha_block_cached__near_ridge_kernel
.p2align 8
.type concat_heads__gqa_block_cached__mha_block_cached__near_ridge_kernel,@function
concat_heads__gqa_block_cached__mha_block_cached__near_ridge_kernel:
s_load_dwordx16 s[4:19], s[0:1], 0
s_load_dwordx8 s[20:27], s[0:1], 64
s_load_dwordx2 s[28:29], s[0:1], 96
s_cmp_ge_u32 s2, 256
s_cbranch_scc1 L_end
v_lshrrev_b32 v1, 6, v0
v_and_b32 v0, 63, v0
v_readfirstlane_b32 s30, v1
s_and_b32 s31, s2, 7
s_lshr_b32 s35, s2, 3
s_lshr_b32 s32, s35, 4
s_and_b32 s35, s35, 15
s_lshr_b32 s33, s35, 1
s_and_b32 s35, s35, 1
s_lshl_b32 s34, s31, 1
s_add_u32 s34, s34, s35
s_lshl_b32 s35, s33, 3
s_add_u32 s35, s35, s31
s_lshl_b32 s36, s33, 4
s_add_u32 s36, s36, s34
s_mul_i32 s78, s30, 4224
s_mul_i32 s38, s30, 28672
s_lshl_b32 s39, s30, 16
s_lshl_b32 s79, s30, 12
v_and_b32 v2, 31, v0
v_lshrrev_b32 v3, 5, v0
v_lshlrev_b32 v4, 2, v3
v_xor_b32 v4, v2, v4
v_lshlrev_b32 v4, 4, v4
v_lshl_add_u32 v240, v3, 13, v4
v_add_u32 v241, 15328, v240
v_add_u32 v242, 30656, v240
v_add_u32 v243, 45984, v240
v_and_b32 v4, 7, v0
v_bfe_u32 v5, v0, 4, 1
v_lshl_or_b32 v5, v3, 2, v5
v_xor_b32 v4, v4, v5
v_lshrrev_b32 v5, 3, v0
v_mul_u32_u24 v5, 896, v5
v_lshl_add_u32 v244, v4, 4, v5
v_add_u32 v245, 6112, v244
v_add_u32 v246, 12224, v244
v_add_u32 v247, 18336, v244
s_lshl_b32 s60, s34, 9
s_mul_i32 s61, s33, 129024
s_sub_u32 s54, 3670016, s60
s_mov_b32 s55, 0x20000
s_mov_b32 s42, 129024
s_mov_b32 s43, 0x20000
s_cmp_eq_u32 s32, 0
s_cselect_b32 s35, s35, s36
s_waitcnt lgkmcnt(0)
s_cselect_b32 s52, s10, s20
s_cselect_b32 s53, s11, s21
s_cselect_b32 s40, s4, s14
s_cselect_b32 s41, s5, s15
s_add_u32 s52, s52, s60
s_addc_u32 s53, s53, 0
s_add_u32 s40, s40, s61
s_addc_u32 s41, s41, 0
s_add_u32 m0, s78, 101376
s_add_u32 s37, s39, 0
buffer_load_dwordx4 v240, s[52:55], s37 offen offset:0 lds
buffer_load_dwordx4 v241, s[52:55], s37 offen offset:1056 lds
buffer_load_dwordx4 v242, s[52:55], s37 offen offset:2112 lds
buffer_load_dwordx4 v243, s[52:55], s37 offen offset:3168 lds
s_add_u32 m0, s78, 135168
s_add_u32 s37, s38, 0
buffer_load_dwordx4 v244, s[40:43], s37 offen offset:0 lds
buffer_load_dwordx4 v245, s[40:43], s37 offen offset:1056 lds
buffer_load_dwordx4 v246, s[40:43], s37 offen offset:2112 lds
buffer_load_dwordx4 v247, s[40:43], s37 offen offset:3168 lds
s_lshl_b32 s36, s30, 8
s_add_u32 m0, s78, 84480
s_add_u32 s37, s36, 114688
buffer_load_dwordx4 v244, s[40:43], s37 offen lds
s_add_u32 s37, s36, 114688
buffer_load_dwordx4 v245, s[40:43], s37 offen offset:1056 lds
s_add_u32 m0, m0, 2112
s_add_u32 s37, s36, 114816
buffer_load_dwordx4 v244, s[40:43], s37 offen lds
s_add_u32 s37, s36, 114816
buffer_load_dwordx4 v245, s[40:43], s37 offen offset:1056 lds
s_add_u32 m0, s78, 118272
s_add_u32 s37, s39, 262144
buffer_load_dwordx4 v240, s[52:55], s37 offen offset:0 lds
buffer_load_dwordx4 v241, s[52:55], s37 offen offset:1056 lds
buffer_load_dwordx4 v242, s[52:55], s37 offen offset:2112 lds
buffer_load_dwordx4 v243, s[52:55], s37 offen offset:3168 lds
s_cmp_eq_u32 s32, 0
s_cselect_b32 s44, s6, s16
s_cselect_b32 s45, s7, s17
s_cselect_b32 s48, s8, s18
s_cselect_b32 s49, s9, s19
s_cselect_b32 s56, s12, s22
s_cselect_b32 s57, s13, s23
s_lshr_b32 s36, s35, 13
s_lshl_b32 s35, s35, 19
s_add_u32 s44, s44, s35
s_addc_u32 s45, s45, s36
s_sub_u32 s44, s44, 96
s_subb_u32 s45, s45, 0
s_mov_b32 s46, 524384
s_mov_b32 s47, 0x20000
s_add_u32 s48, s48, s35
s_addc_u32 s49, s49, s36
s_sub_u32 s48, s48, 96
s_subb_u32 s49, s49, 0
s_mov_b32 s50, 524384
s_mov_b32 s51, 0x20000
s_mul_i32 s35, s34, 229376
s_add_u32 s56, s56, s35
s_addc_u32 s57, s57, 0
s_mov_b32 s58, 229376
s_mov_b32 s59, 0x20000
s_lshl_b32 s16, s32, 3
s_add_u32 s16, s16, s33
s_lshl_b32 s35, s16, 22
s_add_u32 s4, s28, s35
s_addc_u32 s5, s29, 0
s_mov_b32 s6, 2064384
s_mov_b32 s7, 0x20000
s_mul_i32 s35, s34, 129024
s_add_u32 s60, s4, s35
s_addc_u32 s61, s5, 0
s_mov_b32 s62, 129024
s_mov_b32 s63, 0x20000
s_add_u32 s8, s4, 2064384
s_addc_u32 s9, s5, 0
s_mov_b32 s10, 65536
s_mov_b32 s11, 0x20000
s_mov_b32 s12, s24
s_mov_b32 s13, s25
s_mov_b32 s14, 2064384
s_mov_b32 s15, 0x20000
s_lshl_b32 s35, s16, 2
s_add_u32 s18, s26, s35
s_addc_u32 s19, s27, 0
s_mov_b32 s26, 32768
v_mov_b32 v20, 0
v_mov_b32 v21, 0
s_lshl_b32 s35, s34, 2
s_add_u32 s35, s35, s30
s_lshl_b32 s77, s35, 2
s_cbranch_scc1 L_nolead0
buffer_load_dword v21, v20, s[8:11], s26 offen sc1
L_nolead0:
s_getpc_b64 s[20:21]
L_pc:
s_sub_u32 s20, s20, L_pc - concat_heads__gqa_block_cached__mha_block_cached__near_ridge_kernel
s_subb_u32 s21, s21, 0
s_mov_b32 s22, L_code_end - concat_heads__gqa_block_cached__mha_block_cached__near_ridge_kernel
s_mov_b32 s23, 0x20000
v_and_b32 v8, 3, v0
v_lshlrev_b32 v8, 7, v8
s_lshr_b32 s37, s2, 3
s_lshl_b32 s37, s37, 2
s_add_u32 s37, s37, s30
s_lshl_b32 s37, s37, 9
buffer_load_dword v22, v8, s[20:23], s37 offen
v_xor_b32 v4, v2, v3
v_lshlrev_b32 v4, 4, v4
v_lshl_add_u32 v4, v3, 9, v4
v_add_u32 v248, 96, v4
v_add_u32 v249, 64, v4
v_add_u32 v250, 32, v4
v_add_u32 v251, 0, v4
v_lshlrev_b32 v4, 3, v3
v_xor_b32 v4, v2, v4
v_lshlrev_b32 v4, 4, v4
v_lshl_add_u32 v4, v3, 9, v4
v_add_u32 v252, 96, v4
v_add_u32 v253, 64, v4
v_add_u32 v254, 32, v4
v_add_u32 v255, 0, v4
v_and_b32 v52, 15, v0
v_lshrrev_b32 v53, 4, v0
v_lshrrev_b32 v54, 1, v52
v_mul_u32_u24 v54, 1056, v54
v_and_b32 v55, 1, v52
v_lshl_add_u32 v54, v55, 9, v54
v_xor_b32 v55, v53, v55
v_lshl_add_u32 v1, v55, 4, v54
v_lshrrev_b32 v56, 3, v52
v_mul_u32_u24 v54, 1056, v56
v_and_b32 v55, 7, v52
v_lshl_add_u32 v54, v55, 7, v54
v_bfe_u32 v55, v52, 1, 1
v_and_or_b32 v55, v52, 4, v55
v_xor_b32 v55, v53, v55
v_lshl_add_u32 v7, v55, 4, v54
v_xor_b32 v55, 4, v55
v_lshl_add_u32 v8, v55, 4, v54
v_lshrrev_b32 v56, 2, v52
v_and_b32 v57, 3, v52
v_lshrrev_b32 v54, 1, v56
v_lshl_add_u32 v54, v53, 1, v54
v_mul_u32_u24 v54, 1056, v54
v_lshl_add_u32 v54, v57, 3, v54
v_and_b32 v55, 1, v56
v_mul_u32_u24 v2, 640, v55
v_add_u32 v2, v2, v54
v_mul_u32_u24 v3, 384, v55
v_add_u32 v3, v3, v54
v_lshrrev_b32 v54, 1, v56
v_lshl_add_u32 v54, v53, 2, v54
v_mul_u32_u24 v54, 1056, v54
v_lshl_add_u32 v54, v57, 3, v54
s_lshl_b32 s35, s30, 7
v_add_u32 v54, s35, v54
v_mul_u32_u24 v4, 576, v55
v_add_u32 v4, v4, v54
v_mul_u32_u24 v5, 448, v55
v_add_u32 v5, v5, v54
v_lshrrev_b32 v54, 1, v53
v_mul_u32_u24 v54, 1056, v54
v_lshl_add_u32 v54, v57, 3, v54
v_and_b32 v55, 1, v53
v_lshl_add_u32 v55, v55, 2, v56
v_lshl_add_u32 v54, v55, 7, v54
v_lshrrev_b32 v55, 1, v55
v_xor_b32 v55, s30, v55
v_lshl_add_u32 v6, v55, 5, v54
v_lshlrev_b32 v16, 4, v0
v_lshlrev_b32 v17, 3, v0
v_mul_u32_u24 v54, 528, v52
v_lshl_add_u32 v9, v53, 3, v54
s_add_u32 s35, s35, 67584
v_add_u32 v9, s35, v9
v_lshl_add_u32 v19, v53, 4, v54
s_mul_i32 s35, s30, 25344
s_add_u32 s35, s35, 67584
v_add_u32 v19, s35, v19
s_mov_b32 s76, 0x3db8aa3b
s_mul_i32 s67, s30, 4608
s_add_u32 m0, s78, 33792
s_add_u32 s37, s38, 128
buffer_load_dwordx4 v244, s[40:43], s37 offen offset:0 lds
buffer_load_dwordx4 v245, s[40:43], s37 offen offset:1056 lds
buffer_load_dwordx4 v246, s[40:43], s37 offen offset:2112 lds
buffer_load_dwordx4 v247, s[40:43], s37 offen offset:3168 lds
s_add_u32 m0, s78, 0
s_add_u32 s37, s39, 524288
buffer_load_dwordx4 v240, s[52:55], s37 offen offset:0 lds
buffer_load_dwordx4 v241, s[52:55], s37 offen offset:1056 lds
buffer_load_dwordx4 v242, s[52:55], s37 offen offset:2112 lds
buffer_load_dwordx4 v243, s[52:55], s37 offen offset:3168 lds
s_add_u32 m0, s78, 16896
s_add_u32 s37, s39, 786432
buffer_load_dwordx4 v240, s[52:55], s37 offen offset:0 lds
buffer_load_dwordx4 v241, s[52:55], s37 offen offset:1056 lds
buffer_load_dwordx4 v242, s[52:55], s37 offen offset:2112 lds
buffer_load_dwordx4 v243, s[52:55], s37 offen offset:3168 lds
s_waitcnt vmcnt(13)
s_barrier
v_add_u32 v12, 101376, v4
v_add_u32 v13, 101376, v5
v_add_u32 v14, 84480, v7
v_add_u32 v15, 84480, v8
ds_read_b64_tr_b16 a[160:161], v12 offset:0
ds_read_b64_tr_b16 a[162:163], v12 offset:2112
ds_read_b64_tr_b16 a[164:165], v12 offset:32
ds_read_b64_tr_b16 a[166:167], v12 offset:2144
ds_read_b64_tr_b16 a[168:169], v13 offset:64
ds_read_b64_tr_b16 a[170:171], v13 offset:2176
ds_read_b64_tr_b16 a[172:173], v13 offset:96
ds_read_b64_tr_b16 a[174:175], v13 offset:2208
v_add_u32 v10, 135168, v7
s_nop 0
ds_read_b128 v[32:35], v10 offset:0
ds_read_b128 v[36:39], v10 offset:2112
ds_read_b128 v[40:43], v10 offset:4224
ds_read_b128 v[44:47], v10 offset:6336
ds_read_b128 v[48:51], v10 offset:8448
ds_read_b128 v[52:55], v10 offset:10560
ds_read_b128 v[56:59], v10 offset:12672
ds_read_b128 v[60:63], v10 offset:14784
v_add_u32 v11, 135168, v8
s_waitcnt lgkmcnt(6)
v_mfma_f32_16x16x32_bf16 v[96:99], a[160:163], v[32:35], 0
ds_read_b128 v[64:67], v11 offset:0
v_add_u32 v12, 118272, v4
v_mfma_f32_16x16x32_bf16 v[132:135], a[164:167], v[32:35], 0
s_add_u32 m0, s78, 67584
v_add_u32 v13, 118272, v5
v_mfma_f32_16x16x32_bf16 v[168:171], a[168:171], v[32:35], 0
ds_read_b128 a[200:203], v14 offset:0
ds_read_b64_tr_b16 a[176:177], v12 offset:0
v_mfma_f32_16x16x32_bf16 v[204:207], a[172:175], v[32:35], 0
ds_read_b128 a[204:207], v15 offset:0
ds_read_b64_tr_b16 a[178:179], v12 offset:2112
v_mfma_f32_16x16x32_bf16 v[100:103], a[160:163], v[36:39], 0
ds_read_b128 a[208:211], v14 offset:2112
ds_read_b64_tr_b16 a[180:181], v12 offset:32
v_mfma_f32_16x16x32_bf16 v[136:139], a[164:167], v[36:39], 0
ds_read_b128 a[212:215], v15 offset:2112
ds_read_b64_tr_b16 a[182:183], v12 offset:2144
v_mfma_f32_16x16x32_bf16 v[172:175], a[168:171], v[36:39], 0
ds_read_b128 a[216:219], v14 offset:4224
ds_read_b64_tr_b16 a[184:185], v13 offset:64
v_mfma_f32_16x16x32_bf16 v[208:211], a[172:175], v[36:39], 0
ds_read_b128 v[68:71], v11 offset:2112
s_waitcnt lgkmcnt(15)
v_mfma_f32_16x16x32_bf16 v[104:107], a[160:163], v[40:43], 0
ds_read_b128 v[72:75], v11 offset:4224
ds_read_b128 a[220:223], v15 offset:4224
v_mfma_f32_16x16x32_bf16 v[140:143], a[164:167], v[40:43], 0
ds_read_b128 a[224:227], v14 offset:6336
ds_read_b64_tr_b16 a[186:187], v13 offset:2176
v_mfma_f32_16x16x32_bf16 v[176:179], a[168:171], v[40:43], 0
ds_read_b128 a[228:231], v15 offset:6336
ds_read_b64_tr_b16 a[188:189], v13 offset:96
v_mfma_f32_16x16x32_bf16 v[212:215], a[172:175], v[40:43], 0
ds_read_b128 a[232:235], v14 offset:8448
ds_read_b64_tr_b16 a[190:191], v13 offset:2208
v_mfma_f32_16x16x32_bf16 v[108:111], a[160:163], v[44:47], 0
ds_read_b128 a[236:239], v15 offset:8448
s_add_u32 s37, s38, 256
v_mfma_f32_16x16x32_bf16 v[144:147], a[164:167], v[44:47], 0
ds_read_b128 a[240:243], v14 offset:10560
v_accvgpr_write_b32 a159, 0
v_mfma_f32_16x16x32_bf16 v[180:183], a[168:171], v[44:47], 0
ds_read_b128 a[244:247], v15 offset:10560
v_accvgpr_write_b32 a158, 0
v_mfma_f32_16x16x32_bf16 v[216:219], a[172:175], v[44:47], 0
ds_read_b128 v[76:79], v11 offset:6336
s_waitcnt lgkmcnt(15)
v_mfma_f32_16x16x32_bf16 v[112:115], a[160:163], v[48:51], 0
ds_read_b128 v[80:83], v11 offset:8448
ds_read_b128 a[248:251], v14 offset:12672
v_mfma_f32_16x16x32_bf16 v[148:151], a[164:167], v[48:51], 0
ds_read_b128 a[252:255], v15 offset:12672
v_accvgpr_write_b32 a157, 0
v_mfma_f32_16x16x32_bf16 v[184:187], a[168:171], v[48:51], 0
buffer_load_dwordx4 v244, s[40:43], s37 offen offset:0 lds
v_accvgpr_write_b32 a156, 0
v_mfma_f32_16x16x32_bf16 v[220:223], a[172:175], v[48:51], 0
v_mfma_f32_16x16x32_bf16 v[116:119], a[160:163], v[52:55], 0
v_mfma_f32_16x16x32_bf16 v[152:155], a[164:167], v[52:55], 0
v_mfma_f32_16x16x32_bf16 v[188:191], a[168:171], v[52:55], 0
buffer_load_dwordx4 v245, s[40:43], s37 offen offset:1056 lds
v_mfma_f32_16x16x32_bf16 v[224:227], a[172:175], v[52:55], 0
ds_read_b128 v[84:87], v11 offset:10560
s_waitcnt lgkmcnt(15)
v_mfma_f32_16x16x32_bf16 v[120:123], a[160:163], v[56:59], 0
ds_read_b128 v[88:91], v11 offset:12672
v_mfma_f32_16x16x32_bf16 v[156:159], a[164:167], v[56:59], 0
v_mfma_f32_16x16x32_bf16 v[192:195], a[168:171], v[56:59], 0
buffer_load_dwordx4 v246, s[40:43], s37 offen offset:2112 lds
v_mfma_f32_16x16x32_bf16 v[228:231], a[172:175], v[56:59], 0
v_mfma_f32_16x16x32_bf16 v[124:127], a[160:163], v[60:63], 0
v_mfma_f32_16x16x32_bf16 v[160:163], a[164:167], v[60:63], 0
v_mfma_f32_16x16x32_bf16 v[196:199], a[168:171], v[60:63], 0
buffer_load_dwordx4 v247, s[40:43], s37 offen offset:3168 lds
s_add_u32 m0, s78, 50688
v_mfma_f32_16x16x32_bf16 v[232:235], a[172:175], v[60:63], 0
ds_read_b128 v[92:95], v11 offset:14784
s_waitcnt lgkmcnt(3)
v_mfma_f32_16x16x32_bf16 v[128:131], a[160:163], a[200:203], 0
s_add_u32 s37, s39, 1048576
v_add_u32 v12, 0, v4
v_mfma_f32_16x16x32_bf16 v[164:167], a[164:167], a[200:203], 0
buffer_load_dwordx4 v240, s[52:55], s37 offen offset:0 lds
v_add_u32 v13, 0, v5
v_mfma_f32_16x16x32_bf16 v[200:203], a[168:171], a[200:203], 0
v_mfma_f32_16x16x32_bf16 v[236:239], a[172:175], a[200:203], 0
v_mfma_f32_16x16x32_bf16 v[96:99], a[176:179], v[64:67], v[96:99]
v_mfma_f32_16x16x32_bf16 v[132:135], a[180:183], v[64:67], v[132:135]
buffer_load_dwordx4 v241, s[52:55], s37 offen offset:1056 lds
v_mfma_f32_16x16x32_bf16 v[168:171], a[184:187], v[64:67], v[168:171]
v_mfma_f32_16x16x32_bf16 v[204:207], a[188:191], v[64:67], v[204:207]
v_mfma_f32_16x16x32_bf16 v[100:103], a[176:179], v[68:71], v[100:103]
v_mfma_f32_16x16x32_bf16 v[136:139], a[180:183], v[68:71], v[136:139]
buffer_load_dwordx4 v242, s[52:55], s37 offen offset:2112 lds
v_mfma_f32_16x16x32_bf16 v[172:175], a[184:187], v[68:71], v[172:175]
v_mfma_f32_16x16x32_bf16 v[208:211], a[188:191], v[68:71], v[208:211]
v_mfma_f32_16x16x32_bf16 v[104:107], a[176:179], v[72:75], v[104:107]
v_mfma_f32_16x16x32_bf16 v[140:143], a[180:183], v[72:75], v[140:143]
buffer_load_dwordx4 v243, s[52:55], s37 offen offset:3168 lds
v_mfma_f32_16x16x32_bf16 v[176:179], a[184:187], v[72:75], v[176:179]
v_mfma_f32_16x16x32_bf16 v[212:215], a[188:191], v[72:75], v[212:215]
v_mfma_f32_16x16x32_bf16 v[108:111], a[176:179], v[76:79], v[108:111]
v_mfma_f32_16x16x32_bf16 v[144:147], a[180:183], v[76:79], v[144:147]
v_mfma_f32_16x16x32_bf16 v[180:183], a[184:187], v[76:79], v[180:183]
v_mfma_f32_16x16x32_bf16 v[216:219], a[188:191], v[76:79], v[216:219]
s_waitcnt lgkmcnt(2)
v_mfma_f32_16x16x32_bf16 v[112:115], a[176:179], v[80:83], v[112:115]
v_mfma_f32_16x16x32_bf16 v[148:151], a[180:183], v[80:83], v[148:151]
v_mfma_f32_16x16x32_bf16 v[184:187], a[184:187], v[80:83], v[184:187]
v_mfma_f32_16x16x32_bf16 v[220:223], a[188:191], v[80:83], v[220:223]
v_mfma_f32_16x16x32_bf16 v[116:119], a[176:179], v[84:87], v[116:119]
v_mfma_f32_16x16x32_bf16 v[152:155], a[180:183], v[84:87], v[152:155]
v_mfma_f32_16x16x32_bf16 v[188:191], a[184:187], v[84:87], v[188:191]
v_mfma_f32_16x16x32_bf16 v[224:227], a[188:191], v[84:87], v[224:227]
v_add_u32 v10, 33792, v7
s_waitcnt lgkmcnt(0)
v_mfma_f32_16x16x32_bf16 v[120:123], a[176:179], v[88:91], v[120:123]
s_waitcnt vmcnt(8) lgkmcnt(0)
s_barrier
v_mfma_f32_16x16x32_bf16 v[156:159], a[180:183], v[88:91], v[156:159]
ds_read_b128 v[32:35], v10 offset:0
ds_read_b128 v[36:39], v10 offset:2112
s_add_u32 m0, s78, 84480
v_mfma_f32_16x16x32_bf16 v[192:195], a[184:187], v[88:91], v[192:195]
ds_read_b128 v[40:43], v10 offset:4224
ds_read_b128 v[44:47], v10 offset:6336
s_add_u32 s37, s39, 1310720
v_mfma_f32_16x16x32_bf16 v[228:231], a[188:191], v[88:91], v[228:231]
ds_read_b128 v[48:51], v10 offset:8448
ds_read_b128 v[52:55], v10 offset:10560
v_mfma_f32_16x16x32_bf16 v[124:127], a[176:179], v[92:95], v[124:127]
ds_read_b128 v[56:59], v10 offset:12672
ds_read_b128 v[60:63], v10 offset:14784
v_mfma_f32_16x16x32_bf16 v[160:163], a[180:183], v[92:95], v[160:163]
buffer_load_dwordx4 v240, s[52:55], s37 offen offset:0 lds
v_mfma_f32_16x16x32_bf16 v[196:199], a[184:187], v[92:95], v[196:199]
buffer_load_dwordx4 v241, s[52:55], s37 offen offset:1056 lds
v_mfma_f32_16x16x32_bf16 v[232:235], a[188:191], v[92:95], v[232:235]
buffer_load_dwordx4 v242, s[52:55], s37 offen offset:2112 lds
v_mfma_f32_16x16x32_bf16 v[128:131], a[176:179], a[204:207], v[128:131]
buffer_load_dwordx4 v243, s[52:55], s37 offen offset:3168 lds
v_mfma_f32_16x16x32_bf16 v[164:167], a[180:183], a[204:207], v[164:167]
ds_read_b64_tr_b16 a[160:161], v12 offset:0
ds_read_b64_tr_b16 a[162:163], v12 offset:2112
ds_read_b64_tr_b16 a[164:165], v12 offset:32
v_mfma_f32_16x16x32_bf16 v[200:203], a[184:187], a[204:207], v[200:203]
ds_read_b64_tr_b16 a[166:167], v12 offset:2144
ds_read_b64_tr_b16 a[168:169], v13 offset:64
ds_read_b64_tr_b16 a[170:171], v13 offset:2176
v_mfma_f32_16x16x32_bf16 v[236:239], a[188:191], a[204:207], v[236:239]
ds_read_b64_tr_b16 a[172:173], v13 offset:96
ds_read_b64_tr_b16 a[174:175], v13 offset:2208
v_add_u32 v11, 33792, v8
s_waitcnt lgkmcnt(0)
s_cmp_lg_u32 s77, 0
s_cbranch_scc1 L_nolead1
v_add_u32 v21, 1, v21
v_max_u32 v21, 1, v21
buffer_store_dword v21, v20, s[8:11], s26 offen sc1
global_store_dword v20, v21, s[18:19] sc1
L_nolead1:
v_mfma_f32_16x16x32_bf16 v[96:99], a[160:163], v[32:35], v[96:99]
ds_read_b128 v[64:67], v11 offset:0
v_add_u32 v12, 16896, v4
v_mfma_f32_16x16x32_bf16 v[132:135], a[164:167], v[32:35], v[132:135]
s_add_u32 m0, s78, 135168
v_add_u32 v13, 16896, v5
v_mfma_f32_16x16x32_bf16 v[168:171], a[168:171], v[32:35], v[168:171]
ds_read_b64_tr_b16 a[176:177], v12 offset:0
s_add_u32 s37, s38, 384
v_mfma_f32_16x16x32_bf16 v[204:207], a[172:175], v[32:35], v[204:207]
buffer_load_dwordx4 v244, s[40:43], s37 offen offset:0 lds
v_accvgpr_write_b32 a155, 0
v_mfma_f32_16x16x32_bf16 v[100:103], a[160:163], v[36:39], v[100:103]
ds_read_b64_tr_b16 a[178:179], v12 offset:2112
v_accvgpr_write_b32 a154, 0
v_mfma_f32_16x16x32_bf16 v[136:139], a[164:167], v[36:39], v[136:139]
ds_read_b64_tr_b16 a[180:181], v12 offset:32
v_accvgpr_write_b32 a153, 0
v_mfma_f32_16x16x32_bf16 v[172:175], a[168:171], v[36:39], v[172:175]
ds_read_b64_tr_b16 a[182:183], v12 offset:2144
v_accvgpr_write_b32 a152, 0
v_mfma_f32_16x16x32_bf16 v[208:211], a[172:175], v[36:39], v[208:211]
ds_read_b128 v[68:71], v11 offset:2112
s_waitcnt lgkmcnt(10)
v_mfma_f32_16x16x32_bf16 v[104:107], a[160:163], v[40:43], v[104:107]
ds_read_b128 v[72:75], v11 offset:4224
ds_read_b64_tr_b16 a[184:185], v13 offset:64
v_mfma_f32_16x16x32_bf16 v[140:143], a[164:167], v[40:43], v[140:143]
buffer_load_dwordx4 v245, s[40:43], s37 offen offset:1056 lds
v_accvgpr_write_b32 a151, 0
v_mfma_f32_16x16x32_bf16 v[176:179], a[168:171], v[40:43], v[176:179]
ds_read_b64_tr_b16 a[186:187], v13 offset:2176
v_accvgpr_write_b32 a150, 0
v_mfma_f32_16x16x32_bf16 v[212:215], a[172:175], v[40:43], v[212:215]
ds_read_b64_tr_b16 a[188:189], v13 offset:96
v_accvgpr_write_b32 a149, 0
v_mfma_f32_16x16x32_bf16 v[108:111], a[160:163], v[44:47], v[108:111]
ds_read_b64_tr_b16 a[190:191], v13 offset:2208
v_accvgpr_write_b32 a148, 0
v_mfma_f32_16x16x32_bf16 v[144:147], a[164:167], v[44:47], v[144:147]
buffer_load_dwordx4 v246, s[40:43], s37 offen offset:2112 lds
v_accvgpr_write_b32 a147, 0
v_mfma_f32_16x16x32_bf16 v[180:183], a[168:171], v[44:47], v[180:183]
v_accvgpr_write_b32 a146, 0
v_accvgpr_write_b32 a145, 0
v_mfma_f32_16x16x32_bf16 v[216:219], a[172:175], v[44:47], v[216:219]
ds_read_b128 v[76:79], v11 offset:6336
s_waitcnt lgkmcnt(14)
v_mfma_f32_16x16x32_bf16 v[112:115], a[160:163], v[48:51], v[112:115]
ds_read_b128 v[80:83], v11 offset:8448
v_accvgpr_write_b32 a144, 0
v_mfma_f32_16x16x32_bf16 v[148:151], a[164:167], v[48:51], v[148:151]
buffer_load_dwordx4 v247, s[40:43], s37 offen offset:3168 lds
s_add_u32 m0, s78, 101376
v_mfma_f32_16x16x32_bf16 v[184:187], a[168:171], v[48:51], v[184:187]
s_add_u32 s37, s39, 1572864
v_accvgpr_write_b32 a143, 0
v_mfma_f32_16x16x32_bf16 v[220:223], a[172:175], v[48:51], v[220:223]
buffer_load_dwordx4 v240, s[52:55], s37 offen offset:0 lds
v_accvgpr_write_b32 a142, 0
v_mfma_f32_16x16x32_bf16 v[116:119], a[160:163], v[52:55], v[116:119]
v_accvgpr_write_b32 a141, 0
v_accvgpr_write_b32 a140, 0
v_mfma_f32_16x16x32_bf16 v[152:155], a[164:167], v[52:55], v[152:155]
v_accvgpr_write_b32 a139, 0
v_accvgpr_write_b32 a138, 0
v_mfma_f32_16x16x32_bf16 v[188:191], a[168:171], v[52:55], v[188:191]
v_accvgpr_write_b32 a137, 0
v_accvgpr_write_b32 a136, 0
v_mfma_f32_16x16x32_bf16 v[224:227], a[172:175], v[52:55], v[224:227]
ds_read_b128 v[84:87], v11 offset:10560
s_waitcnt lgkmcnt(14)
v_mfma_f32_16x16x32_bf16 v[120:123], a[160:163], v[56:59], v[120:123]
ds_read_b128 v[88:91], v11 offset:12672
v_accvgpr_write_b32 a135, 0
v_mfma_f32_16x16x32_bf16 v[156:159], a[164:167], v[56:59], v[156:159]
buffer_load_dwordx4 v241, s[52:55], s37 offen offset:1056 lds
v_accvgpr_write_b32 a134, 0
v_mfma_f32_16x16x32_bf16 v[192:195], a[168:171], v[56:59], v[192:195]
v_accvgpr_write_b32 a133, 0
v_accvgpr_write_b32 a132, 0
v_mfma_f32_16x16x32_bf16 v[228:231], a[172:175], v[56:59], v[228:231]
v_accvgpr_write_b32 a131, 0
v_accvgpr_write_b32 a130, 0
v_mfma_f32_16x16x32_bf16 v[124:127], a[160:163], v[60:63], v[124:127]
ds_read_b128 v[92:95], v11 offset:14784
v_accvgpr_write_b32 a129, 0
v_mfma_f32_16x16x32_bf16 v[160:163], a[164:167], v[60:63], v[160:163]
buffer_load_dwordx4 v242, s[52:55], s37 offen offset:2112 lds
v_accvgpr_write_b32 a128, 0
v_mfma_f32_16x16x32_bf16 v[196:199], a[168:171], v[60:63], v[196:199]
v_add_u32 v12, 50688, v4
v_add_u32 v13, 50688, v5
v_mfma_f32_16x16x32_bf16 v[232:235], a[172:175], v[60:63], v[232:235]
v_accvgpr_write_b32 a127, 0
v_accvgpr_write_b32 a126, 0
v_mfma_f32_16x16x32_bf16 v[128:131], a[160:163], a[208:211], v[128:131]
v_accvgpr_write_b32 a125, 0
v_accvgpr_write_b32 a124, 0
v_mfma_f32_16x16x32_bf16 v[164:167], a[164:167], a[208:211], v[164:167]
buffer_load_dwordx4 v243, s[52:55], s37 offen offset:3168 lds
s_add_u32 m0, s78, 118272
v_mfma_f32_16x16x32_bf16 v[200:203], a[168:171], a[208:211], v[200:203]
s_add_u32 s37, s39, 1835008
v_add_u32 v10, 67584, v7
v_mfma_f32_16x16x32_bf16 v[236:239], a[172:175], a[208:211], v[236:239]
s_waitcnt vmcnt(8) lgkmcnt(0)
s_barrier
s_waitcnt lgkmcnt(5)
v_mfma_f32_16x16x32_bf16 v[96:99], a[176:179], v[64:67], v[96:99]
ds_read_b128 v[32:35], v10 offset:0
ds_read_b64_tr_b16 a[160:161], v12 offset:0
v_mfma_f32_16x16x32_bf16 v[132:135], a[180:183], v[64:67], v[132:135]
buffer_load_dwordx4 v240, s[52:55], s37 offen offset:0 lds
v_mfma_f32_16x16x32_bf16 v[168:171], a[184:187], v[64:67], v[168:171]
ds_read_b64_tr_b16 a[162:163], v12 offset:2112
v_mfma_f32_16x16x32_bf16 v[204:207], a[188:191], v[64:67], v[204:207]
ds_read_b64_tr_b16 a[164:165], v12 offset:32
v_mfma_f32_16x16x32_bf16 v[100:103], a[176:179], v[68:71], v[100:103]
ds_read_b64_tr_b16 a[166:167], v12 offset:2144
v_mfma_f32_16x16x32_bf16 v[136:139], a[180:183], v[68:71], v[136:139]
buffer_load_dwordx4 v241, s[52:55], s37 offen offset:1056 lds
v_mfma_f32_16x16x32_bf16 v[172:175], a[184:187], v[68:71], v[172:175]
ds_read_b64_tr_b16 a[168:169], v13 offset:64
v_mfma_f32_16x16x32_bf16 v[208:211], a[188:191], v[68:71], v[208:211]
ds_read_b128 v[36:39], v10 offset:2112
s_waitcnt lgkmcnt(11)
v_mfma_f32_16x16x32_bf16 v[104:107], a[176:179], v[72:75], v[104:107]
ds_read_b128 v[40:43], v10 offset:4224
ds_read_b64_tr_b16 a[170:171], v13 offset:2176
v_mfma_f32_16x16x32_bf16 v[140:143], a[180:183], v[72:75], v[140:143]
buffer_load_dwordx4 v242, s[52:55], s37 offen offset:2112 lds
v_mfma_f32_16x16x32_bf16 v[176:179], a[184:187], v[72:75], v[176:179]
ds_read_b64_tr_b16 a[172:173], v13 offset:96
v_mfma_f32_16x16x32_bf16 v[212:215], a[188:191], v[72:75], v[212:215]
ds_read_b64_tr_b16 a[174:175], v13 offset:2208
v_mfma_f32_16x16x32_bf16 v[108:111], a[176:179], v[76:79], v[108:111]
v_mfma_f32_16x16x32_bf16 v[144:147], a[180:183], v[76:79], v[144:147]
buffer_load_dwordx4 v243, s[52:55], s37 offen offset:3168 lds
s_add_u32 m0, s78, 33792
v_mfma_f32_16x16x32_bf16 v[180:183], a[184:187], v[76:79], v[180:183]
s_add_u32 s37, s38, 512
v_mfma_f32_16x16x32_bf16 v[216:219], a[188:191], v[76:79], v[216:219]
ds_read_b128 v[44:47], v10 offset:6336
s_waitcnt lgkmcnt(14)
v_mfma_f32_16x16x32_bf16 v[112:115], a[176:179], v[80:83], v[112:115]
ds_read_b128 v[48:51], v10 offset:8448
v_mfma_f32_16x16x32_bf16 v[148:151], a[180:183], v[80:83], v[148:151]
buffer_load_dwordx4 v244, s[40:43], s37 offen offset:0 lds
v_mfma_f32_16x16x32_bf16 v[184:187], a[184:187], v[80:83], v[184:187]
v_mfma_f32_16x16x32_bf16 v[220:223], a[188:191], v[80:83], v[220:223]
v_mfma_f32_16x16x32_bf16 v[116:119], a[176:179], v[84:87], v[116:119]
v_mfma_f32_16x16x32_bf16 v[152:155], a[180:183], v[84:87], v[152:155]
buffer_load_dwordx4 v245, s[40:43], s37 offen offset:1056 lds
v_mfma_f32_16x16x32_bf16 v[188:191], a[184:187], v[84:87], v[188:191]
v_mfma_f32_16x16x32_bf16 v[224:227], a[188:191], v[84:87], v[224:227]
ds_read_b128 v[52:55], v10 offset:10560
s_waitcnt lgkmcnt(14)
v_mfma_f32_16x16x32_bf16 v[120:123], a[176:179], v[88:91], v[120:123]
ds_read_b128 v[56:59], v10 offset:12672
v_mfma_f32_16x16x32_bf16 v[156:159], a[180:183], v[88:91], v[156:159]
buffer_load_dwordx4 v246, s[40:43], s37 offen offset:2112 lds
v_mfma_f32_16x16x32_bf16 v[192:195], a[184:187], v[88:91], v[192:195]
v_mfma_f32_16x16x32_bf16 v[228:231], a[188:191], v[88:91], v[228:231]
v_mfma_f32_16x16x32_bf16 v[124:127], a[176:179], v[92:95], v[124:127]
ds_read_b128 v[60:63], v10 offset:14784
v_mfma_f32_16x16x32_bf16 v[160:163], a[180:183], v[92:95], v[160:163]
buffer_load_dwordx4 v247, s[40:43], s37 offen offset:3168 lds
v_mfma_f32_16x16x32_bf16 v[196:199], a[184:187], v[92:95], v[196:199]
v_mfma_f32_16x16x32_bf16 v[232:235], a[188:191], v[92:95], v[232:235]
v_mfma_f32_16x16x32_bf16 v[128:131], a[176:179], a[212:215], v[128:131]
v_mfma_f32_16x16x32_bf16 v[164:167], a[180:183], a[212:215], v[164:167]
v_mfma_f32_16x16x32_bf16 v[200:203], a[184:187], a[212:215], v[200:203]
v_mfma_f32_16x16x32_bf16 v[236:239], a[188:191], a[212:215], v[236:239]
v_add_u32 v11, 67584, v8
s_waitcnt lgkmcnt(5)
v_mfma_f32_16x16x32_bf16 v[96:99], a[160:163], v[32:35], v[96:99]
ds_read_b128 v[64:67], v11 offset:0
v_add_u32 v12, 84480, v4
v_mfma_f32_16x16x32_bf16 v[132:135], a[164:167], v[32:35], v[132:135]
s_add_u32 m0, s78, 0
v_add_u32 v13, 84480, v5
v_mfma_f32_16x16x32_bf16 v[168:171], a[168:171], v[32:35], v[168:171]
ds_read_b64_tr_b16 a[176:177], v12 offset:0
s_add_u32 s37, s39, 2097152
v_mfma_f32_16x16x32_bf16 v[204:207], a[172:175], v[32:35], v[204:207]
ds_read_b64_tr_b16 a[178:179], v12 offset:2112
v_accvgpr_write_b32 a123, 0
v_mfma_f32_16x16x32_bf16 v[100:103], a[160:163], v[36:39], v[100:103]
ds_read_b64_tr_b16 a[180:181], v12 offset:32
v_accvgpr_write_b32 a122, 0
v_mfma_f32_16x16x32_bf16 v[136:139], a[164:167], v[36:39], v[136:139]
buffer_load_dwordx4 v240, s[52:55], s37 offen offset:0 lds
v_accvgpr_write_b32 a121, 0
v_mfma_f32_16x16x32_bf16 v[172:175], a[168:171], v[36:39], v[172:175]
ds_read_b64_tr_b16 a[182:183], v12 offset:2144
v_accvgpr_write_b32 a120, 0
v_mfma_f32_16x16x32_bf16 v[208:211], a[172:175], v[36:39], v[208:211]
ds_read_b128 v[68:71], v11 offset:2112
s_waitcnt lgkmcnt(10)
v_mfma_f32_16x16x32_bf16 v[104:107], a[160:163], v[40:43], v[104:107]
ds_read_b128 v[72:75], v11 offset:4224
ds_read_b64_tr_b16 a[184:185], v13 offset:64
v_mfma_f32_16x16x32_bf16 v[140:143], a[164:167], v[40:43], v[140:143]
ds_read_b64_tr_b16 a[186:187], v13 offset:2176
v_accvgpr_write_b32 a119, 0
v_mfma_f32_16x16x32_bf16 v[176:179], a[168:171], v[40:43], v[176:179]
ds_read_b64_tr_b16 a[188:189], v13 offset:96
v_accvgpr_write_b32 a118, 0
v_mfma_f32_16x16x32_bf16 v[212:215], a[172:175], v[40:43], v[212:215]
ds_read_b64_tr_b16 a[190:191], v13 offset:2208
v_accvgpr_write_b32 a117, 0
v_mfma_f32_16x16x32_bf16 v[108:111], a[160:163], v[44:47], v[108:111]
buffer_load_dwordx4 v241, s[52:55], s37 offen offset:1056 lds
v_accvgpr_write_b32 a116, 0
v_mfma_f32_16x16x32_bf16 v[144:147], a[164:167], v[44:47], v[144:147]
v_accvgpr_write_b32 a115, 0
v_accvgpr_write_b32 a114, 0
v_mfma_f32_16x16x32_bf16 v[180:183], a[168:171], v[44:47], v[180:183]
v_accvgpr_write_b32 a113, 0
v_accvgpr_write_b32 a112, 0
v_mfma_f32_16x16x32_bf16 v[216:219], a[172:175], v[44:47], v[216:219]
ds_read_b128 v[76:79], v11 offset:6336
s_waitcnt lgkmcnt(14)
v_mfma_f32_16x16x32_bf16 v[112:115], a[160:163], v[48:51], v[112:115]
ds_read_b128 v[80:83], v11 offset:8448
v_accvgpr_write_b32 a111, 0
v_mfma_f32_16x16x32_bf16 v[148:151], a[164:167], v[48:51], v[148:151]
buffer_load_dwordx4 v242, s[52:55], s37 offen offset:2112 lds
v_accvgpr_write_b32 a110, 0
v_mfma_f32_16x16x32_bf16 v[184:187], a[168:171], v[48:51], v[184:187]
v_accvgpr_write_b32 a109, 0
v_accvgpr_write_b32 a108, 0
v_mfma_f32_16x16x32_bf16 v[220:223], a[172:175], v[48:51], v[220:223]
v_accvgpr_write_b32 a107, 0
v_accvgpr_write_b32 a106, 0
v_mfma_f32_16x16x32_bf16 v[116:119], a[160:163], v[52:55], v[116:119]
v_accvgpr_write_b32 a105, 0
v_accvgpr_write_b32 a104, 0
v_mfma_f32_16x16x32_bf16 v[152:155], a[164:167], v[52:55], v[152:155]
v_accvgpr_write_b32 a103, 0
v_accvgpr_write_b32 a102, 0
v_mfma_f32_16x16x32_bf16 v[188:191], a[168:171], v[52:55], v[188:191]
buffer_load_dwordx4 v243, s[52:55], s37 offen offset:3168 lds
s_add_u32 m0, s78, 16896
v_mfma_f32_16x16x32_bf16 v[224:227], a[172:175], v[52:55], v[224:227]
ds_read_b128 v[84:87], v11 offset:10560
s_waitcnt lgkmcnt(14)
v_mfma_f32_16x16x32_bf16 v[120:123], a[160:163], v[56:59], v[120:123]
ds_read_b128 v[88:91], v11 offset:12672
s_add_u32 s37, s39, 2359296
v_mfma_f32_16x16x32_bf16 v[156:159], a[164:167], v[56:59], v[156:159]
buffer_load_dwordx4 v240, s[52:55], s37 offen offset:0 lds
v_accvgpr_write_b32 a101, 0
v_mfma_f32_16x16x32_bf16 v[192:195], a[168:171], v[56:59], v[192:195]
v_accvgpr_write_b32 a100, 0
v_accvgpr_write_b32 a99, 0
v_mfma_f32_16x16x32_bf16 v[228:231], a[172:175], v[56:59], v[228:231]
v_accvgpr_write_b32 a98, 0
v_accvgpr_write_b32 a97, 0
v_mfma_f32_16x16x32_bf16 v[124:127], a[160:163], v[60:63], v[124:127]
ds_read_b128 v[92:95], v11 offset:14784
v_accvgpr_write_b32 a96, 0
v_mfma_f32_16x16x32_bf16 v[160:163], a[164:167], v[60:63], v[160:163]
v_accvgpr_write_b32 a95, 0
v_accvgpr_write_b32 a94, 0
v_mfma_f32_16x16x32_bf16 v[196:199], a[168:171], v[60:63], v[196:199]
v_add_u32 v12, 101376, v4
v_add_u32 v13, 101376, v5
v_mfma_f32_16x16x32_bf16 v[232:235], a[172:175], v[60:63], v[232:235]
buffer_load_dwordx4 v241, s[52:55], s37 offen offset:1056 lds
v_accvgpr_write_b32 a93, 0
v_mfma_f32_16x16x32_bf16 v[128:131], a[160:163], a[216:219], v[128:131]
v_accvgpr_write_b32 a92, 0
v_mfma_f32_16x16x32_bf16 v[164:167], a[164:167], a[216:219], v[164:167]
v_mfma_f32_16x16x32_bf16 v[200:203], a[168:171], a[216:219], v[200:203]
v_add_u32 v10, 135168, v7
v_mfma_f32_16x16x32_bf16 v[236:239], a[172:175], a[216:219], v[236:239]
s_waitcnt vmcnt(10) lgkmcnt(0)
s_barrier
s_waitcnt lgkmcnt(5)
v_mfma_f32_16x16x32_bf16 v[96:99], a[176:179], v[64:67], v[96:99]
ds_read_b128 v[32:35], v10 offset:0
ds_read_b64_tr_b16 a[160:161], v12 offset:0
v_mfma_f32_16x16x32_bf16 v[132:135], a[180:183], v[64:67], v[132:135]
buffer_load_dwordx4 v242, s[52:55], s37 offen offset:2112 lds
v_mfma_f32_16x16x32_bf16 v[168:171], a[184:187], v[64:67], v[168:171]
ds_read_b64_tr_b16 a[162:163], v12 offset:2112
v_mfma_f32_16x16x32_bf16 v[204:207], a[188:191], v[64:67], v[204:207]
ds_read_b64_tr_b16 a[164:165], v12 offset:32
v_mfma_f32_16x16x32_bf16 v[100:103], a[176:179], v[68:71], v[100:103]
ds_read_b64_tr_b16 a[166:167], v12 offset:2144
v_mfma_f32_16x16x32_bf16 v[136:139], a[180:183], v[68:71], v[136:139]
ds_read_b64_tr_b16 a[168:169], v13 offset:64
v_mfma_f32_16x16x32_bf16 v[172:175], a[184:187], v[68:71], v[172:175]
buffer_load_dwordx4 v243, s[52:55], s37 offen offset:3168 lds
s_add_u32 m0, s78, 84480
v_mfma_f32_16x16x32_bf16 v[208:211], a[188:191], v[68:71], v[208:211]
ds_read_b128 v[36:39], v10 offset:2112
s_waitcnt lgkmcnt(11)
v_mfma_f32_16x16x32_bf16 v[104:107], a[176:179], v[72:75], v[104:107]
ds_read_b128 v[40:43], v10 offset:4224
s_add_u32 s37, s38, 640
v_mfma_f32_16x16x32_bf16 v[140:143], a[180:183], v[72:75], v[140:143]
buffer_load_dwordx4 v244, s[40:43], s37 offen offset:0 lds
v_mfma_f32_16x16x32_bf16 v[176:179], a[184:187], v[72:75], v[176:179]
ds_read_b64_tr_b16 a[170:171], v13 offset:2176
v_mfma_f32_16x16x32_bf16 v[212:215], a[188:191], v[72:75], v[212:215]
ds_read_b64_tr_b16 a[172:173], v13 offset:96
v_mfma_f32_16x16x32_bf16 v[108:111], a[176:179], v[76:79], v[108:111]
ds_read_b64_tr_b16 a[174:175], v13 offset:2208
v_mfma_f32_16x16x32_bf16 v[144:147], a[180:183], v[76:79], v[144:147]
v_mfma_f32_16x16x32_bf16 v[180:183], a[184:187], v[76:79], v[180:183]
buffer_load_dwordx4 v245, s[40:43], s37 offen offset:1056 lds
v_mfma_f32_16x16x32_bf16 v[216:219], a[188:191], v[76:79], v[216:219]
ds_read_b128 v[44:47], v10 offset:6336
s_waitcnt lgkmcnt(14)
v_mfma_f32_16x16x32_bf16 v[112:115], a[176:179], v[80:83], v[112:115]
ds_read_b128 v[48:51], v10 offset:8448
v_mfma_f32_16x16x32_bf16 v[148:151], a[180:183], v[80:83], v[148:151]
v_mfma_f32_16x16x32_bf16 v[184:187], a[184:187], v[80:83], v[184:187]
v_mfma_f32_16x16x32_bf16 v[220:223], a[188:191], v[80:83], v[220:223]
buffer_load_dwordx4 v246, s[40:43], s37 offen offset:2112 lds
v_mfma_f32_16x16x32_bf16 v[116:119], a[176:179], v[84:87], v[116:119]
v_mfma_f32_16x16x32_bf16 v[152:155], a[180:183], v[84:87], v[152:155]
v_mfma_f32_16x16x32_bf16 v[188:191], a[184:187], v[84:87], v[188:191]
v_mfma_f32_16x16x32_bf16 v[224:227], a[188:191], v[84:87], v[224:227]
ds_read_b128 v[52:55], v10 offset:10560
s_waitcnt lgkmcnt(14)
v_mfma_f32_16x16x32_bf16 v[120:123], a[176:179], v[88:91], v[120:123]
ds_read_b128 v[56:59], v10 offset:12672
v_mfma_f32_16x16x32_bf16 v[156:159], a[180:183], v[88:91], v[156:159]
buffer_load_dwordx4 v247, s[40:43], s37 offen offset:3168 lds
v_mfma_f32_16x16x32_bf16 v[192:195], a[184:187], v[88:91], v[192:195]
v_mfma_f32_16x16x32_bf16 v[228:231], a[188:191], v[88:91], v[228:231]
v_mfma_f32_16x16x32_bf16 v[124:127], a[176:179], v[92:95], v[124:127]
ds_read_b128 v[60:63], v10 offset:14784
v_mfma_f32_16x16x32_bf16 v[160:163], a[180:183], v[92:95], v[160:163]
v_mfma_f32_16x16x32_bf16 v[196:199], a[184:187], v[92:95], v[196:199]
v_mfma_f32_16x16x32_bf16 v[232:235], a[188:191], v[92:95], v[232:235]
v_mfma_f32_16x16x32_bf16 v[128:131], a[176:179], a[220:223], v[128:131]
v_mfma_f32_16x16x32_bf16 v[164:167], a[180:183], a[220:223], v[164:167]
v_mfma_f32_16x16x32_bf16 v[200:203], a[184:187], a[220:223], v[200:203]
v_mfma_f32_16x16x32_bf16 v[236:239], a[188:191], a[220:223], v[236:239]
v_add_u32 v11, 135168, v8
s_waitcnt lgkmcnt(5)
v_mfma_f32_16x16x32_bf16 v[96:99], a[160:163], v[32:35], v[96:99]
ds_read_b128 v[64:67], v11 offset:0
v_add_u32 v12, 118272, v4
v_mfma_f32_16x16x32_bf16 v[132:135], a[164:167], v[32:35], v[132:135]
s_add_u32 m0, s78, 50688
v_add_u32 v13, 118272, v5
v_mfma_f32_16x16x32_bf16 v[168:171], a[168:171], v[32:35], v[168:171]
ds_read_b64_tr_b16 a[176:177], v12 offset:0
s_add_u32 s37, s39, 2621440
v_mfma_f32_16x16x32_bf16 v[204:207], a[172:175], v[32:35], v[204:207]
ds_read_b64_tr_b16 a[178:179], v12 offset:2112
v_accvgpr_write_b32 a91, 0
v_mfma_f32_16x16x32_bf16 v[100:103], a[160:163], v[36:39], v[100:103]
ds_read_b64_tr_b16 a[180:181], v12 offset:32
v_accvgpr_write_b32 a90, 0
v_mfma_f32_16x16x32_bf16 v[136:139], a[164:167], v[36:39], v[136:139]
buffer_load_dwordx4 v240, s[52:55], s37 offen offset:0 lds
v_accvgpr_write_b32 a89, 0
v_mfma_f32_16x16x32_bf16 v[172:175], a[168:171], v[36:39], v[172:175]
ds_read_b64_tr_b16 a[182:183], v12 offset:2144
v_accvgpr_write_b32 a88, 0
v_mfma_f32_16x16x32_bf16 v[208:211], a[172:175], v[36:39], v[208:211]
ds_read_b128 v[68:71], v11 offset:2112
s_waitcnt lgkmcnt(10)
v_mfma_f32_16x16x32_bf16 v[104:107], a[160:163], v[40:43], v[104:107]
ds_read_b128 v[72:75], v11 offset:4224
ds_read_b64_tr_b16 a[184:185], v13 offset:64
v_mfma_f32_16x16x32_bf16 v[140:143], a[164:167], v[40:43], v[140:143]
ds_read_b64_tr_b16 a[186:187], v13 offset:2176
v_accvgpr_write_b32 a87, 0
v_mfma_f32_16x16x32_bf16 v[176:179], a[168:171], v[40:43], v[176:179]
ds_read_b64_tr_b16 a[188:189], v13 offset:96
v_accvgpr_write_b32 a86, 0
v_mfma_f32_16x16x32_bf16 v[212:215], a[172:175], v[40:43], v[212:215]
ds_read_b64_tr_b16 a[190:191], v13 offset:2208
v_accvgpr_write_b32 a85, 0
v_mfma_f32_16x16x32_bf16 v[108:111], a[160:163], v[44:47], v[108:111]
buffer_load_dwordx4 v241, s[52:55], s37 offen offset:1056 lds
v_accvgpr_write_b32 a84, 0
v_mfma_f32_16x16x32_bf16 v[144:147], a[164:167], v[44:47], v[144:147]
v_accvgpr_write_b32 a83, 0
v_accvgpr_write_b32 a82, 0
v_mfma_f32_16x16x32_bf16 v[180:183], a[168:171], v[44:47], v[180:183]
v_accvgpr_write_b32 a81, 0
v_accvgpr_write_b32 a80, 0
v_mfma_f32_16x16x32_bf16 v[216:219], a[172:175], v[44:47], v[216:219]
ds_read_b128 v[76:79], v11 offset:6336
s_waitcnt lgkmcnt(14)
v_mfma_f32_16x16x32_bf16 v[112:115], a[160:163], v[48:51], v[112:115]
ds_read_b128 v[80:83], v11 offset:8448
v_accvgpr_write_b32 a79, 0
v_mfma_f32_16x16x32_bf16 v[148:151], a[164:167], v[48:51], v[148:151]
buffer_load_dwordx4 v242, s[52:55], s37 offen offset:2112 lds
v_accvgpr_write_b32 a78, 0
v_mfma_f32_16x16x32_bf16 v[184:187], a[168:171], v[48:51], v[184:187]
v_accvgpr_write_b32 a77, 0
v_accvgpr_write_b32 a76, 0
v_mfma_f32_16x16x32_bf16 v[220:223], a[172:175], v[48:51], v[220:223]
v_accvgpr_write_b32 a75, 0
v_accvgpr_write_b32 a74, 0
v_mfma_f32_16x16x32_bf16 v[116:119], a[160:163], v[52:55], v[116:119]
v_accvgpr_write_b32 a73, 0
v_accvgpr_write_b32 a72, 0
v_mfma_f32_16x16x32_bf16 v[152:155], a[164:167], v[52:55], v[152:155]
v_accvgpr_write_b32 a71, 0
v_accvgpr_write_b32 a70, 0
v_mfma_f32_16x16x32_bf16 v[188:191], a[168:171], v[52:55], v[188:191]
buffer_load_dwordx4 v243, s[52:55], s37 offen offset:3168 lds
s_add_u32 m0, s78, 67584
v_mfma_f32_16x16x32_bf16 v[224:227], a[172:175], v[52:55], v[224:227]
ds_read_b128 v[84:87], v11 offset:10560
s_waitcnt lgkmcnt(14)
v_mfma_f32_16x16x32_bf16 v[120:123], a[160:163], v[56:59], v[120:123]
ds_read_b128 v[88:91], v11 offset:12672
s_add_u32 s37, s39, 2883584
v_mfma_f32_16x16x32_bf16 v[156:159], a[164:167], v[56:59], v[156:159]
buffer_load_dwordx4 v240, s[52:55], s37 offen offset:0 lds
v_accvgpr_write_b32 a69, 0
v_mfma_f32_16x16x32_bf16 v[192:195], a[168:171], v[56:59], v[192:195]
v_accvgpr_write_b32 a68, 0
v_accvgpr_write_b32 a67, 0
v_mfma_f32_16x16x32_bf16 v[228:231], a[172:175], v[56:59], v[228:231]
v_accvgpr_write_b32 a66, 0
v_accvgpr_write_b32 a65, 0
v_mfma_f32_16x16x32_bf16 v[124:127], a[160:163], v[60:63], v[124:127]
ds_read_b128 v[92:95], v11 offset:14784
v_accvgpr_write_b32 a64, 0
v_mfma_f32_16x16x32_bf16 v[160:163], a[164:167], v[60:63], v[160:163]
v_accvgpr_write_b32 a63, 0
v_accvgpr_write_b32 a62, 0
v_mfma_f32_16x16x32_bf16 v[196:199], a[168:171], v[60:63], v[196:199]
v_add_u32 v12, 0, v4
v_add_u32 v13, 0, v5
v_mfma_f32_16x16x32_bf16 v[232:235], a[172:175], v[60:63], v[232:235]
buffer_load_dwordx4 v241, s[52:55], s37 offen offset:1056 lds
v_accvgpr_write_b32 a61, 0
v_mfma_f32_16x16x32_bf16 v[128:131], a[160:163], a[224:227], v[128:131]
v_accvgpr_write_b32 a60, 0
v_mfma_f32_16x16x32_bf16 v[164:167], a[164:167], a[224:227], v[164:167]
v_mfma_f32_16x16x32_bf16 v[200:203], a[168:171], a[224:227], v[200:203]
v_add_u32 v10, 33792, v7
v_mfma_f32_16x16x32_bf16 v[236:239], a[172:175], a[224:227], v[236:239]
s_waitcnt vmcnt(10) lgkmcnt(0)
s_barrier
s_waitcnt lgkmcnt(5)
v_mfma_f32_16x16x32_bf16 v[96:99], a[176:179], v[64:67], v[96:99]
ds_read_b128 v[32:35], v10 offset:0
ds_read_b64_tr_b16 a[160:161], v12 offset:0
v_mfma_f32_16x16x32_bf16 v[132:135], a[180:183], v[64:67], v[132:135]
buffer_load_dwordx4 v242, s[52:55], s37 offen offset:2112 lds
v_mfma_f32_16x16x32_bf16 v[168:171], a[184:187], v[64:67], v[168:171]
ds_read_b64_tr_b16 a[162:163], v12 offset:2112
v_mfma_f32_16x16x32_bf16 v[204:207], a[188:191], v[64:67], v[204:207]
ds_read_b64_tr_b16 a[164:165], v12 offset:32
v_mfma_f32_16x16x32_bf16 v[100:103], a[176:179], v[68:71], v[100:103]
ds_read_b64_tr_b16 a[166:167], v12 offset:2144
v_mfma_f32_16x16x32_bf16 v[136:139], a[180:183], v[68:71], v[136:139]
ds_read_b64_tr_b16 a[168:169], v13 offset:64
v_mfma_f32_16x16x32_bf16 v[172:175], a[184:187], v[68:71], v[172:175]
buffer_load_dwordx4 v243, s[52:55], s37 offen offset:3168 lds
s_add_u32 m0, s78, 135168
v_mfma_f32_16x16x32_bf16 v[208:211], a[188:191], v[68:71], v[208:211]
ds_read_b128 v[36:39], v10 offset:2112
s_waitcnt lgkmcnt(11)
v_mfma_f32_16x16x32_bf16 v[104:107], a[176:179], v[72:75], v[104:107]
ds_read_b128 v[40:43], v10 offset:4224
s_add_u32 s37, s38, 768
v_mfma_f32_16x16x32_bf16 v[140:143], a[180:183], v[72:75], v[140:143]
buffer_load_dwordx4 v244, s[40:43], s37 offen offset:0 lds
v_mfma_f32_16x16x32_bf16 v[176:179], a[184:187], v[72:75], v[176:179]
ds_read_b64_tr_b16 a[170:171], v13 offset:2176
v_mfma_f32_16x16x32_bf16 v[212:215], a[188:191], v[72:75], v[212:215]
ds_read_b64_tr_b16 a[172:173], v13 offset:96
v_mfma_f32_16x16x32_bf16 v[108:111], a[176:179], v[76:79], v[108:111]
ds_read_b64_tr_b16 a[174:175], v13 offset:2208
v_mfma_f32_16x16x32_bf16 v[144:147], a[180:183], v[76:79], v[144:147]
v_mfma_f32_16x16x32_bf16 v[180:183], a[184:187], v[76:79], v[180:183]
buffer_load_dwordx4 v245, s[40:43], s37 offen offset:1056 lds
v_mfma_f32_16x16x32_bf16 v[216:219], a[188:191], v[76:79], v[216:219]
ds_read_b128 v[44:47], v10 offset:6336
s_waitcnt lgkmcnt(14)
v_mfma_f32_16x16x32_bf16 v[112:115], a[176:179], v[80:83], v[112:115]
ds_read_b128 v[48:51], v10 offset:8448
v_mfma_f32_16x16x32_bf16 v[148:151], a[180:183], v[80:83], v[148:151]
v_mfma_f32_16x16x32_bf16 v[184:187], a[184:187], v[80:83], v[184:187]
v_mfma_f32_16x16x32_bf16 v[220:223], a[188:191], v[80:83], v[220:223]
buffer_load_dwordx4 v246, s[40:43], s37 offen offset:2112 lds
v_mfma_f32_16x16x32_bf16 v[116:119], a[176:179], v[84:87], v[116:119]
v_mfma_f32_16x16x32_bf16 v[152:155], a[180:183], v[84:87], v[152:155]
v_mfma_f32_16x16x32_bf16 v[188:191], a[184:187], v[84:87], v[188:191]
v_mfma_f32_16x16x32_bf16 v[224:227], a[188:191], v[84:87], v[224:227]
ds_read_b128 v[52:55], v10 offset:10560
s_waitcnt lgkmcnt(14)
v_mfma_f32_16x16x32_bf16 v[120:123], a[176:179], v[88:91], v[120:123]
ds_read_b128 v[56:59], v10 offset:12672
v_mfma_f32_16x16x32_bf16 v[156:159], a[180:183], v[88:91], v[156:159]
buffer_load_dwordx4 v247, s[40:43], s37 offen offset:3168 lds
v_mfma_f32_16x16x32_bf16 v[192:195], a[184:187], v[88:91], v[192:195]
v_mfma_f32_16x16x32_bf16 v[228:231], a[188:191], v[88:91], v[228:231]
v_mfma_f32_16x16x32_bf16 v[124:127], a[176:179], v[92:95], v[124:127]
ds_read_b128 v[60:63], v10 offset:14784
v_mfma_f32_16x16x32_bf16 v[160:163], a[180:183], v[92:95], v[160:163]
v_mfma_f32_16x16x32_bf16 v[196:199], a[184:187], v[92:95], v[196:199]
v_mfma_f32_16x16x32_bf16 v[232:235], a[188:191], v[92:95], v[232:235]
v_mfma_f32_16x16x32_bf16 v[128:131], a[176:179], a[228:231], v[128:131]
v_mfma_f32_16x16x32_bf16 v[164:167], a[180:183], a[228:231], v[164:167]
v_mfma_f32_16x16x32_bf16 v[200:203], a[184:187], a[228:231], v[200:203]
v_mfma_f32_16x16x32_bf16 v[236:239], a[188:191], a[228:231], v[236:239]
v_add_u32 v11, 33792, v8
s_waitcnt lgkmcnt(5)
v_mfma_f32_16x16x32_bf16 v[96:99], a[160:163], v[32:35], v[96:99]
ds_read_b128 v[64:67], v11 offset:0
v_add_u32 v12, 16896, v4
v_mfma_f32_16x16x32_bf16 v[132:135], a[164:167], v[32:35], v[132:135]
s_add_u32 m0, s78, 101376
v_add_u32 v13, 16896, v5
v_mfma_f32_16x16x32_bf16 v[168:171], a[168:171], v[32:35], v[168:171]
ds_read_b64_tr_b16 a[176:177], v12 offset:0
s_add_u32 s37, s39, 3145728
v_mfma_f32_16x16x32_bf16 v[204:207], a[172:175], v[32:35], v[204:207]
ds_read_b64_tr_b16 a[178:179], v12 offset:2112
v_accvgpr_write_b32 a59, 0
v_mfma_f32_16x16x32_bf16 v[100:103], a[160:163], v[36:39], v[100:103]
ds_read_b64_tr_b16 a[180:181], v12 offset:32
v_accvgpr_write_b32 a58, 0
v_mfma_f32_16x16x32_bf16 v[136:139], a[164:167], v[36:39], v[136:139]
buffer_load_dwordx4 v240, s[52:55], s37 offen offset:0 lds
v_accvgpr_write_b32 a57, 0
v_mfma_f32_16x16x32_bf16 v[172:175], a[168:171], v[36:39], v[172:175]
ds_read_b64_tr_b16 a[182:183], v12 offset:2144
v_accvgpr_write_b32 a56, 0
v_mfma_f32_16x16x32_bf16 v[208:211], a[172:175], v[36:39], v[208:211]
ds_read_b128 v[68:71], v11 offset:2112
s_waitcnt lgkmcnt(10)
v_mfma_f32_16x16x32_bf16 v[104:107], a[160:163], v[40:43], v[104:107]
ds_read_b128 v[72:75], v11 offset:4224
ds_read_b64_tr_b16 a[184:185], v13 offset:64
v_mfma_f32_16x16x32_bf16 v[140:143], a[164:167], v[40:43], v[140:143]
ds_read_b64_tr_b16 a[186:187], v13 offset:2176
v_accvgpr_write_b32 a55, 0
v_mfma_f32_16x16x32_bf16 v[176:179], a[168:171], v[40:43], v[176:179]
ds_read_b64_tr_b16 a[188:189], v13 offset:96
v_accvgpr_write_b32 a54, 0
v_mfma_f32_16x16x32_bf16 v[212:215], a[172:175], v[40:43], v[212:215]
ds_read_b64_tr_b16 a[190:191], v13 offset:2208
v_accvgpr_write_b32 a53, 0
v_mfma_f32_16x16x32_bf16 v[108:111], a[160:163], v[44:47], v[108:111]
buffer_load_dwordx4 v241, s[52:55], s37 offen offset:1056 lds
v_accvgpr_write_b32 a52, 0
v_mfma_f32_16x16x32_bf16 v[144:147], a[164:167], v[44:47], v[144:147]
v_accvgpr_write_b32 a51, 0
v_accvgpr_write_b32 a50, 0
v_mfma_f32_16x16x32_bf16 v[180:183], a[168:171], v[44:47], v[180:183]
v_accvgpr_write_b32 a49, 0
v_accvgpr_write_b32 a48, 0
v_mfma_f32_16x16x32_bf16 v[216:219], a[172:175], v[44:47], v[216:219]
ds_read_b128 v[76:79], v11 offset:6336
s_waitcnt lgkmcnt(14)
v_mfma_f32_16x16x32_bf16 v[112:115], a[160:163], v[48:51], v[112:115]
ds_read_b128 v[80:83], v11 offset:8448
v_accvgpr_write_b32 a47, 0
v_mfma_f32_16x16x32_bf16 v[148:151], a[164:167], v[48:51], v[148:151]
buffer_load_dwordx4 v242, s[52:55], s37 offen offset:2112 lds
v_accvgpr_write_b32 a46, 0
v_mfma_f32_16x16x32_bf16 v[184:187], a[168:171], v[48:51], v[184:187]
v_accvgpr_write_b32 a45, 0
v_accvgpr_write_b32 a44, 0
v_mfma_f32_16x16x32_bf16 v[220:223], a[172:175], v[48:51], v[220:223]
v_accvgpr_write_b32 a43, 0
v_accvgpr_write_b32 a42, 0
v_mfma_f32_16x16x32_bf16 v[116:119], a[160:163], v[52:55], v[116:119]
v_accvgpr_write_b32 a41, 0
v_accvgpr_write_b32 a40, 0
v_mfma_f32_16x16x32_bf16 v[152:155], a[164:167], v[52:55], v[152:155]
v_accvgpr_write_b32 a39, 0
v_accvgpr_write_b32 a38, 0
v_mfma_f32_16x16x32_bf16 v[188:191], a[168:171], v[52:55], v[188:191]
buffer_load_dwordx4 v243, s[52:55], s37 offen offset:3168 lds
s_add_u32 m0, s78, 118272
v_mfma_f32_16x16x32_bf16 v[224:227], a[172:175], v[52:55], v[224:227]
ds_read_b128 v[84:87], v11 offset:10560
s_waitcnt lgkmcnt(14)
v_mfma_f32_16x16x32_bf16 v[120:123], a[160:163], v[56:59], v[120:123]
ds_read_b128 v[88:91], v11 offset:12672
s_add_u32 s37, s39, 3407872
v_mfma_f32_16x16x32_bf16 v[156:159], a[164:167], v[56:59], v[156:159]
buffer_load_dwordx4 v240, s[52:55], s37 offen offset:0 lds
v_accvgpr_write_b32 a37, 0
v_mfma_f32_16x16x32_bf16 v[192:195], a[168:171], v[56:59], v[192:195]
v_accvgpr_write_b32 a36, 0
v_accvgpr_write_b32 a35, 0
v_mfma_f32_16x16x32_bf16 v[228:231], a[172:175], v[56:59], v[228:231]
v_accvgpr_write_b32 a34, 0
v_accvgpr_write_b32 a33, 0
v_mfma_f32_16x16x32_bf16 v[124:127], a[160:163], v[60:63], v[124:127]
ds_read_b128 v[92:95], v11 offset:14784
v_accvgpr_write_b32 a32, 0
v_mfma_f32_16x16x32_bf16 v[160:163], a[164:167], v[60:63], v[160:163]
v_accvgpr_write_b32 a31, 0
v_accvgpr_write_b32 a30, 0
v_mfma_f32_16x16x32_bf16 v[196:199], a[168:171], v[60:63], v[196:199]
v_add_u32 v12, 50688, v4
v_add_u32 v13, 50688, v5
v_mfma_f32_16x16x32_bf16 v[232:235], a[172:175], v[60:63], v[232:235]
buffer_load_dwordx4 v241, s[52:55], s37 offen offset:1056 lds
v_accvgpr_write_b32 a29, 0
v_mfma_f32_16x16x32_bf16 v[128:131], a[160:163], a[232:235], v[128:131]
v_accvgpr_write_b32 a28, 0
v_mfma_f32_16x16x32_bf16 v[164:167], a[164:167], a[232:235], v[164:167]
v_mfma_f32_16x16x32_bf16 v[200:203], a[168:171], a[232:235], v[200:203]
v_add_u32 v10, 84480, v7
v_mfma_f32_16x16x32_bf16 v[236:239], a[172:175], a[232:235], v[236:239]
s_waitcnt vmcnt(10) lgkmcnt(0)
s_barrier
s_waitcnt lgkmcnt(5)
v_mfma_f32_16x16x32_bf16 v[96:99], a[176:179], v[64:67], v[96:99]
ds_read_b128 v[32:35], v10 offset:0
ds_read_b64_tr_b16 a[160:161], v12 offset:0
v_mfma_f32_16x16x32_bf16 v[132:135], a[180:183], v[64:67], v[132:135]
buffer_load_dwordx4 v242, s[52:55], s37 offen offset:2112 lds
v_mfma_f32_16x16x32_bf16 v[168:171], a[184:187], v[64:67], v[168:171]
ds_read_b64_tr_b16 a[162:163], v12 offset:2112
v_mfma_f32_16x16x32_bf16 v[204:207], a[188:191], v[64:67], v[204:207]
ds_read_b64_tr_b16 a[164:165], v12 offset:32
v_mfma_f32_16x16x32_bf16 v[100:103], a[176:179], v[68:71], v[100:103]
ds_read_b64_tr_b16 a[166:167], v12 offset:2144
v_mfma_f32_16x16x32_bf16 v[136:139], a[180:183], v[68:71], v[136:139]
ds_read_b64_tr_b16 a[168:169], v13 offset:64
v_mfma_f32_16x16x32_bf16 v[172:175], a[184:187], v[68:71], v[172:175]
buffer_load_dwordx4 v243, s[52:55], s37 offen offset:3168 lds
s_add_u32 m0, s78, 0
v_mfma_f32_16x16x32_bf16 v[208:211], a[188:191], v[68:71], v[208:211]
ds_read_b128 v[36:39], v10 offset:2112
s_waitcnt lgkmcnt(11)
v_mfma_f32_16x16x32_bf16 v[104:107], a[176:179], v[72:75], v[104:107]
ds_read_b128 v[40:43], v10 offset:4224
s_add_u32 s37, s79, 0
v_mfma_f32_16x16x32_bf16 v[140:143], a[180:183], v[72:75], v[140:143]
buffer_load_dwordx4 v248, s[44:47], s37 offen offset:0 nt lds
v_mfma_f32_16x16x32_bf16 v[176:179], a[184:187], v[72:75], v[176:179]
ds_read_b64_tr_b16 a[170:171], v13 offset:2176
v_mfma_f32_16x16x32_bf16 v[212:215], a[188:191], v[72:75], v[212:215]
ds_read_b64_tr_b16 a[172:173], v13 offset:96
v_mfma_f32_16x16x32_bf16 v[108:111], a[176:179], v[76:79], v[108:111]
ds_read_b64_tr_b16 a[174:175], v13 offset:2208
v_mfma_f32_16x16x32_bf16 v[144:147], a[180:183], v[76:79], v[144:147]
v_mfma_f32_16x16x32_bf16 v[180:183], a[184:187], v[76:79], v[180:183]
buffer_load_dwordx4 v249, s[44:47], s37 offen offset:1056 nt lds
v_mfma_f32_16x16x32_bf16 v[216:219], a[188:191], v[76:79], v[216:219]
ds_read_b128 v[44:47], v10 offset:6336
s_waitcnt lgkmcnt(14)
v_mfma_f32_16x16x32_bf16 v[112:115], a[176:179], v[80:83], v[112:115]
ds_read_b128 v[48:51], v10 offset:8448
v_mfma_f32_16x16x32_bf16 v[148:151], a[180:183], v[80:83], v[148:151]
v_mfma_f32_16x16x32_bf16 v[184:187], a[184:187], v[80:83], v[184:187]
v_mfma_f32_16x16x32_bf16 v[220:223], a[188:191], v[80:83], v[220:223]
buffer_load_dwordx4 v250, s[44:47], s37 offen offset:2112 nt lds
v_mfma_f32_16x16x32_bf16 v[116:119], a[176:179], v[84:87], v[116:119]
v_mfma_f32_16x16x32_bf16 v[152:155], a[180:183], v[84:87], v[152:155]
v_mfma_f32_16x16x32_bf16 v[188:191], a[184:187], v[84:87], v[188:191]
v_mfma_f32_16x16x32_bf16 v[224:227], a[188:191], v[84:87], v[224:227]
ds_read_b128 v[52:55], v10 offset:10560
s_waitcnt lgkmcnt(14)
v_mfma_f32_16x16x32_bf16 v[120:123], a[176:179], v[88:91], v[120:123]
ds_read_b128 v[56:59], v10 offset:12672
v_mfma_f32_16x16x32_bf16 v[156:159], a[180:183], v[88:91], v[156:159]
buffer_load_dwordx4 v251, s[44:47], s37 offen offset:3168 nt lds
v_mfma_f32_16x16x32_bf16 v[192:195], a[184:187], v[88:91], v[192:195]
v_mfma_f32_16x16x32_bf16 v[228:231], a[188:191], v[88:91], v[228:231]
v_mfma_f32_16x16x32_bf16 v[124:127], a[176:179], v[92:95], v[124:127]
ds_read_b128 v[60:63], v10 offset:14784
v_mfma_f32_16x16x32_bf16 v[160:163], a[180:183], v[92:95], v[160:163]
v_mfma_f32_16x16x32_bf16 v[196:199], a[184:187], v[92:95], v[196:199]
v_mfma_f32_16x16x32_bf16 v[232:235], a[188:191], v[92:95], v[232:235]
v_mfma_f32_16x16x32_bf16 v[128:131], a[176:179], a[236:239], v[128:131]
v_mfma_f32_16x16x32_bf16 v[164:167], a[180:183], a[236:239], v[164:167]
v_mfma_f32_16x16x32_bf16 v[200:203], a[184:187], a[236:239], v[200:203]
v_mfma_f32_16x16x32_bf16 v[236:239], a[188:191], a[236:239], v[236:239]
v_add_u32 v11, 84480, v8
s_waitcnt lgkmcnt(5)
v_mfma_f32_16x16x32_bf16 v[96:99], a[160:163], v[32:35], v[96:99]
ds_read_b128 v[64:67], v11 offset:0
v_add_u32 v12, 67584, v4
v_mfma_f32_16x16x32_bf16 v[132:135], a[164:167], v[32:35], v[132:135]
s_add_u32 m0, s78, 16896
v_add_u32 v13, 67584, v5
v_mfma_f32_16x16x32_bf16 v[168:171], a[168:171], v[32:35], v[168:171]
ds_read_b64_tr_b16 a[176:177], v12 offset:0
s_add_u32 s37, s79, 16384
v_mfma_f32_16x16x32_bf16 v[204:207], a[172:175], v[32:35], v[204:207]
ds_read_b64_tr_b16 a[178:179], v12 offset:2112
v_accvgpr_write_b32 a27, 0
v_mfma_f32_16x16x32_bf16 v[100:103], a[160:163], v[36:39], v[100:103]
ds_read_b64_tr_b16 a[180:181], v12 offset:32
v_accvgpr_write_b32 a26, 0
v_mfma_f32_16x16x32_bf16 v[136:139], a[164:167], v[36:39], v[136:139]
buffer_load_dwordx4 v248, s[44:47], s37 offen offset:0 nt lds
v_accvgpr_write_b32 a25, 0
v_mfma_f32_16x16x32_bf16 v[172:175], a[168:171], v[36:39], v[172:175]
ds_read_b64_tr_b16 a[182:183], v12 offset:2144
v_accvgpr_write_b32 a24, 0
v_mfma_f32_16x16x32_bf16 v[208:211], a[172:175], v[36:39], v[208:211]
ds_read_b128 v[68:71], v11 offset:2112
s_waitcnt lgkmcnt(10)
v_mfma_f32_16x16x32_bf16 v[104:107], a[160:163], v[40:43], v[104:107]
ds_read_b128 v[72:75], v11 offset:4224
ds_read_b64_tr_b16 a[184:185], v13 offset:64
v_mfma_f32_16x16x32_bf16 v[140:143], a[164:167], v[40:43], v[140:143]
ds_read_b64_tr_b16 a[186:187], v13 offset:2176
v_accvgpr_write_b32 a23, 0
v_mfma_f32_16x16x32_bf16 v[176:179], a[168:171], v[40:43], v[176:179]
ds_read_b64_tr_b16 a[188:189], v13 offset:96
v_accvgpr_write_b32 a22, 0
v_mfma_f32_16x16x32_bf16 v[212:215], a[172:175], v[40:43], v[212:215]
ds_read_b64_tr_b16 a[190:191], v13 offset:2208
v_accvgpr_write_b32 a21, 0
v_mfma_f32_16x16x32_bf16 v[108:111], a[160:163], v[44:47], v[108:111]
buffer_load_dwordx4 v249, s[44:47], s37 offen offset:1056 nt lds
v_accvgpr_write_b32 a20, 0
v_mfma_f32_16x16x32_bf16 v[144:147], a[164:167], v[44:47], v[144:147]
v_accvgpr_write_b32 a19, 0
v_accvgpr_write_b32 a18, 0
v_mfma_f32_16x16x32_bf16 v[180:183], a[168:171], v[44:47], v[180:183]
v_accvgpr_write_b32 a17, 0
v_accvgpr_write_b32 a16, 0
v_mfma_f32_16x16x32_bf16 v[216:219], a[172:175], v[44:47], v[216:219]
ds_read_b128 v[76:79], v11 offset:6336
s_waitcnt lgkmcnt(14)
v_mfma_f32_16x16x32_bf16 v[112:115], a[160:163], v[48:51], v[112:115]
ds_read_b128 v[80:83], v11 offset:8448
v_accvgpr_write_b32 a15, 0
v_mfma_f32_16x16x32_bf16 v[148:151], a[164:167], v[48:51], v[148:151]
buffer_load_dwordx4 v250, s[44:47], s37 offen offset:2112 nt lds
v_accvgpr_write_b32 a14, 0
v_mfma_f32_16x16x32_bf16 v[184:187], a[168:171], v[48:51], v[184:187]
v_accvgpr_write_b32 a13, 0
v_accvgpr_write_b32 a12, 0
v_mfma_f32_16x16x32_bf16 v[220:223], a[172:175], v[48:51], v[220:223]
v_accvgpr_write_b32 a11, 0
v_accvgpr_write_b32 a10, 0
v_mfma_f32_16x16x32_bf16 v[116:119], a[160:163], v[52:55], v[116:119]
v_accvgpr_write_b32 a9, 0
v_accvgpr_write_b32 a8, 0
v_mfma_f32_16x16x32_bf16 v[152:155], a[164:167], v[52:55], v[152:155]
v_accvgpr_write_b32 a7, 0
v_accvgpr_write_b32 a6, 0
v_mfma_f32_16x16x32_bf16 v[188:191], a[168:171], v[52:55], v[188:191]
buffer_load_dwordx4 v251, s[44:47], s37 offen offset:3168 nt lds
s_add_u32 m0, s78, 33792
v_mfma_f32_16x16x32_bf16 v[224:227], a[172:175], v[52:55], v[224:227]
ds_read_b128 v[84:87], v11 offset:10560
s_waitcnt lgkmcnt(14)
v_mfma_f32_16x16x32_bf16 v[120:123], a[160:163], v[56:59], v[120:123]
ds_read_b128 v[88:91], v11 offset:12672
s_add_u32 s37, s79, 0
v_mfma_f32_16x16x32_bf16 v[156:159], a[164:167], v[56:59], v[156:159]
buffer_load_dwordx4 v252, s[48:51], s37 offen offset:0 nt lds
v_accvgpr_write_b32 a5, 0
v_mfma_f32_16x16x32_bf16 v[192:195], a[168:171], v[56:59], v[192:195]
v_accvgpr_write_b32 a4, 0
v_accvgpr_write_b32 a3, 0
v_mfma_f32_16x16x32_bf16 v[228:231], a[172:175], v[56:59], v[228:231]
v_accvgpr_write_b32 a2, 0
v_accvgpr_write_b32 a1, 0
v_mfma_f32_16x16x32_bf16 v[124:127], a[160:163], v[60:63], v[124:127]
ds_read_b128 v[92:95], v11 offset:14784
v_accvgpr_write_b32 a0, 0
v_mfma_f32_16x16x32_bf16 v[160:163], a[164:167], v[60:63], v[160:163]
v_mfma_f32_16x16x32_bf16 v[196:199], a[168:171], v[60:63], v[196:199]
v_add_u32 v12, 101376, v4
v_add_u32 v13, 101376, v5
v_mfma_f32_16x16x32_bf16 v[232:235], a[172:175], v[60:63], v[232:235]
buffer_load_dwordx4 v253, s[48:51], s37 offen offset:1056 nt lds
v_mfma_f32_16x16x32_bf16 v[128:131], a[160:163], a[240:243], v[128:131]
v_mfma_f32_16x16x32_bf16 v[164:167], a[164:167], a[240:243], v[164:167]
v_mfma_f32_16x16x32_bf16 v[200:203], a[168:171], a[240:243], v[200:203]
v_add_u32 v10, 135168, v7
v_add_u32 v11, 135168, v8
v_mfma_f32_16x16x32_bf16 v[236:239], a[172:175], a[240:243], v[236:239]
s_waitcnt vmcnt(10) lgkmcnt(0)
s_barrier
s_waitcnt lgkmcnt(5)
v_mfma_f32_16x16x32_bf16 v[96:99], a[176:179], v[64:67], v[96:99]
ds_read_b128 v[32:35], v10 offset:0
ds_read_b64_tr_b16 a[160:161], v12 offset:0
v_mfma_f32_16x16x32_bf16 v[132:135], a[180:183], v[64:67], v[132:135]
buffer_load_dwordx4 v254, s[48:51], s37 offen offset:2112 nt lds
v_mfma_f32_16x16x32_bf16 v[168:171], a[184:187], v[64:67], v[168:171]
ds_read_b64_tr_b16 a[162:163], v12 offset:2112
v_mfma_f32_16x16x32_bf16 v[204:207], a[188:191], v[64:67], v[204:207]
ds_read_b64_tr_b16 a[164:165], v12 offset:32
v_mfma_f32_16x16x32_bf16 v[100:103], a[176:179], v[68:71], v[100:103]
ds_read_b64_tr_b16 a[166:167], v12 offset:2144
v_mfma_f32_16x16x32_bf16 v[136:139], a[180:183], v[68:71], v[136:139]
ds_read_b64_tr_b16 a[168:169], v13 offset:64
v_mfma_f32_16x16x32_bf16 v[172:175], a[184:187], v[68:71], v[172:175]
buffer_load_dwordx4 v255, s[48:51], s37 offen offset:3168 nt lds
s_add_u32 m0, s78, 50688
v_mfma_f32_16x16x32_bf16 v[208:211], a[188:191], v[68:71], v[208:211]
ds_read_b128 v[36:39], v10 offset:2112
s_waitcnt lgkmcnt(11)
v_mfma_f32_16x16x32_bf16 v[104:107], a[176:179], v[72:75], v[104:107]
ds_read_b128 v[40:43], v10 offset:4224
s_add_u32 s37, s79, 32768
v_mfma_f32_16x16x32_bf16 v[140:143], a[180:183], v[72:75], v[140:143]
buffer_load_dwordx4 v248, s[44:47], s37 offen offset:0 nt lds
v_mfma_f32_16x16x32_bf16 v[176:179], a[184:187], v[72:75], v[176:179]
ds_read_b64_tr_b16 a[170:171], v13 offset:2176
v_mfma_f32_16x16x32_bf16 v[212:215], a[188:191], v[72:75], v[212:215]
ds_read_b64_tr_b16 a[172:173], v13 offset:96
v_mfma_f32_16x16x32_bf16 v[108:111], a[176:179], v[76:79], v[108:111]
ds_read_b64_tr_b16 a[174:175], v13 offset:2208
v_mfma_f32_16x16x32_bf16 v[144:147], a[180:183], v[76:79], v[144:147]
v_mfma_f32_16x16x32_bf16 v[180:183], a[184:187], v[76:79], v[180:183]
buffer_load_dwordx4 v249, s[44:47], s37 offen offset:1056 nt lds
v_mfma_f32_16x16x32_bf16 v[216:219], a[188:191], v[76:79], v[216:219]
ds_read_b128 v[44:47], v11 offset:0
s_waitcnt lgkmcnt(14)
v_mfma_f32_16x16x32_bf16 v[112:115], a[176:179], v[80:83], v[112:115]
ds_read_b128 v[48:51], v11 offset:2112
v_mfma_f32_16x16x32_bf16 v[148:151], a[180:183], v[80:83], v[148:151]
v_mfma_f32_16x16x32_bf16 v[184:187], a[184:187], v[80:83], v[184:187]
v_mfma_f32_16x16x32_bf16 v[220:223], a[188:191], v[80:83], v[220:223]
buffer_load_dwordx4 v250, s[44:47], s37 offen offset:2112 nt lds
v_mfma_f32_16x16x32_bf16 v[116:119], a[176:179], v[84:87], v[116:119]
v_mfma_f32_16x16x32_bf16 v[152:155], a[180:183], v[84:87], v[152:155]
v_mfma_f32_16x16x32_bf16 v[188:191], a[184:187], v[84:87], v[188:191]
v_mfma_f32_16x16x32_bf16 v[224:227], a[188:191], v[84:87], v[224:227]
ds_read_b128 v[52:55], v11 offset:4224
s_waitcnt lgkmcnt(14)
v_mfma_f32_16x16x32_bf16 v[120:123], a[176:179], v[88:91], v[120:123]
ds_read_b128 v[56:59], v10 offset:6336
v_mfma_f32_16x16x32_bf16 v[156:159], a[180:183], v[88:91], v[156:159]
buffer_load_dwordx4 v251, s[44:47], s37 offen offset:3168 nt lds
v_mfma_f32_16x16x32_bf16 v[192:195], a[184:187], v[88:91], v[192:195]
v_mfma_f32_16x16x32_bf16 v[228:231], a[188:191], v[88:91], v[228:231]
v_mfma_f32_16x16x32_bf16 v[124:127], a[176:179], v[92:95], v[124:127]
ds_read_b128 v[60:63], v11 offset:6336
v_mfma_f32_16x16x32_bf16 v[160:163], a[180:183], v[92:95], v[160:163]
v_mfma_f32_16x16x32_bf16 v[196:199], a[184:187], v[92:95], v[196:199]
v_mfma_f32_16x16x32_bf16 v[232:235], a[188:191], v[92:95], v[232:235]
v_mfma_f32_16x16x32_bf16 v[128:131], a[176:179], a[244:247], v[128:131]
v_mfma_f32_16x16x32_bf16 v[164:167], a[180:183], a[244:247], v[164:167]
v_mfma_f32_16x16x32_bf16 v[200:203], a[184:187], a[244:247], v[200:203]
v_mfma_f32_16x16x32_bf16 v[236:239], a[188:191], a[244:247], v[236:239]
s_waitcnt lgkmcnt(5)
v_mfma_f32_16x16x32_bf16 v[96:99], a[160:163], v[32:35], v[96:99]
ds_read_b128 v[64:67], v10 offset:8448
v_add_u32 v12, 118272, v4
v_add_u32 v13, 118272, v5
v_mfma_f32_16x16x32_bf16 v[132:135], a[164:167], v[32:35], v[132:135]
ds_read_b64_tr_b16 a[176:177], v12 offset:0
ds_read_b64_tr_b16 a[178:179], v12 offset:2112
v_mfma_f32_16x16x32_bf16 v[168:171], a[168:171], v[32:35], v[168:171]
ds_read_b64_tr_b16 a[180:181], v12 offset:32
ds_read_b64_tr_b16 a[182:183], v12 offset:2144
v_mfma_f32_16x16x32_bf16 v[204:207], a[172:175], v[32:35], v[204:207]
ds_read_b64_tr_b16 a[184:185], v13 offset:64
ds_read_b64_tr_b16 a[186:187], v13 offset:2176
v_mfma_f32_16x16x32_bf16 v[100:103], a[160:163], v[36:39], v[100:103]
ds_read_b64_tr_b16 a[188:189], v13 offset:96
ds_read_b64_tr_b16 a[190:191], v13 offset:2208
v_mfma_f32_16x16x32_bf16 v[136:139], a[164:167], v[36:39], v[136:139]
v_add_u32 v14, 42240, v9
v_mfma_f32_16x16x32_bf16 v[172:175], a[168:171], v[36:39], v[172:175]
v_mfma_f32_16x16x32_bf16 v[208:211], a[172:175], v[36:39], v[208:211]
ds_read_b128 v[68:71], v11 offset:8448
s_waitcnt lgkmcnt(14)
v_mfma_f32_16x16x32_bf16 v[104:107], a[160:163], v[40:43], v[104:107]
v_mfma_f32_16x16x32_bf16 v[140:143], a[164:167], v[40:43], v[140:143]
v_mfma_f32_16x16x32_bf16 v[176:179], a[168:171], v[40:43], v[176:179]
v_mfma_f32_16x16x32_bf16 v[212:215], a[172:175], v[40:43], v[212:215]
ds_read_b128 v[72:75], v10 offset:10560
s_waitcnt lgkmcnt(2)
v_mfma_f32_16x16x32_bf16 v[96:99], a[176:179], v[44:47], v[96:99]
v_mfma_f32_16x16x32_bf16 v[132:135], a[180:183], v[44:47], v[132:135]
v_mfma_f32_16x16x32_bf16 v[168:171], a[184:187], v[44:47], v[168:171]
v_mfma_f32_16x16x32_bf16 v[204:207], a[188:191], v[44:47], v[204:207]
ds_read_b128 v[76:79], v11 offset:10560
v_mfma_f32_16x16x32_bf16 v[100:103], a[176:179], v[48:51], v[100:103]
ds_read_b128 v[80:83], v10 offset:12672
v_mfma_f32_16x16x32_bf16 v[136:139], a[180:183], v[48:51], v[136:139]
v_mfma_f32_16x16x32_bf16 v[172:175], a[184:187], v[48:51], v[172:175]
v_mfma_f32_16x16x32_bf16 v[208:211], a[188:191], v[48:51], v[208:211]
v_mul_f32 v96, s76, v96
v_mul_f32 v97, s76, v97
v_mfma_f32_16x16x32_bf16 v[104:107], a[176:179], v[52:55], v[104:107]
v_mul_f32 v98, s76, v98
v_mul_f32 v99, s76, v99
v_mfma_f32_16x16x32_bf16 v[140:143], a[180:183], v[52:55], v[140:143]
v_cvt_pk_bf16_f32 v96, v96, v97
v_cvt_pk_bf16_f32 v97, v98, v99
v_mfma_f32_16x16x32_bf16 v[176:179], a[184:187], v[52:55], v[176:179]
v_mul_f32 v132, s76, v132
v_mul_f32 v133, s76, v133
v_mfma_f32_16x16x32_bf16 v[212:215], a[188:191], v[52:55], v[212:215]
ds_read_b128 v[84:87], v11 offset:12672
v_mfma_f32_16x16x32_bf16 v[108:111], a[160:163], v[56:59], v[108:111]
ds_read_b128 v[88:91], v10 offset:14784
v_mul_f32 v134, s76, v134
v_mfma_f32_16x16x32_bf16 v[144:147], a[164:167], v[56:59], v[144:147]
v_mul_f32 v135, s76, v135
v_cvt_pk_bf16_f32 v132, v132, v133
v_mfma_f32_16x16x32_bf16 v[180:183], a[168:171], v[56:59], v[180:183]
v_cvt_pk_bf16_f32 v133, v134, v135
v_mul_f32 v168, s76, v168
v_mfma_f32_16x16x32_bf16 v[216:219], a[172:175], v[56:59], v[216:219]
v_mul_f32 v169, s76, v169
v_mul_f32 v170, s76, v170
v_mfma_f32_16x16x32_bf16 v[108:111], a[176:179], v[60:63], v[108:111]
v_mul_f32 v171, s76, v171
v_cvt_pk_bf16_f32 v168, v168, v169
v_mfma_f32_16x16x32_bf16 v[144:147], a[180:183], v[60:63], v[144:147]
v_cvt_pk_bf16_f32 v169, v170, v171
v_mul_f32 v204, s76, v204
v_mfma_f32_16x16x32_bf16 v[180:183], a[184:187], v[60:63], v[180:183]
v_mul_f32 v205, s76, v205
v_mul_f32 v206, s76, v206
v_mfma_f32_16x16x32_bf16 v[216:219], a[188:191], v[60:63], v[216:219]
ds_read_b128 v[92:95], v11 offset:14784
s_waitcnt lgkmcnt(6)
v_mfma_f32_16x16x32_bf16 v[112:115], a[160:163], v[64:67], v[112:115]
v_mul_f32 v207, s76, v207
v_cvt_pk_bf16_f32 v204, v204, v205
v_mfma_f32_16x16x32_bf16 v[148:151], a[164:167], v[64:67], v[148:151]
v_cvt_pk_bf16_f32 v205, v206, v207
v_mul_f32 v100, s76, v100
v_mfma_f32_16x16x32_bf16 v[184:187], a[168:171], v[64:67], v[184:187]
v_mul_f32 v101, s76, v101
v_mul_f32 v102, s76, v102
v_mfma_f32_16x16x32_bf16 v[220:223], a[172:175], v[64:67], v[220:223]
v_mul_f32 v103, s76, v103
v_cvt_pk_bf16_f32 v100, v100, v101
v_mfma_f32_16x16x32_bf16 v[112:115], a[176:179], v[68:71], v[112:115]
v_cvt_pk_bf16_f32 v101, v102, v103
v_mul_f32 v136, s76, v136
v_mfma_f32_16x16x32_bf16 v[148:151], a[180:183], v[68:71], v[148:151]
v_mul_f32 v137, s76, v137
v_mul_f32 v138, s76, v138
v_mfma_f32_16x16x32_bf16 v[184:187], a[184:187], v[68:71], v[184:187]
v_mul_f32 v139, s76, v139
v_cvt_pk_bf16_f32 v136, v136, v137
v_mfma_f32_16x16x32_bf16 v[220:223], a[188:191], v[68:71], v[220:223]
v_cvt_pk_bf16_f32 v137, v138, v139
s_waitcnt lgkmcnt(4)
v_mfma_f32_16x16x32_bf16 v[116:119], a[160:163], v[72:75], v[116:119]
v_mul_f32 v172, s76, v172
v_mul_f32 v173, s76, v173
v_mfma_f32_16x16x32_bf16 v[152:155], a[164:167], v[72:75], v[152:155]
v_mul_f32 v174, s76, v174
v_mul_f32 v175, s76, v175
v_mfma_f32_16x16x32_bf16 v[188:191], a[168:171], v[72:75], v[188:191]
v_cvt_pk_bf16_f32 v172, v172, v173
v_cvt_pk_bf16_f32 v173, v174, v175
v_mfma_f32_16x16x32_bf16 v[224:227], a[172:175], v[72:75], v[224:227]
v_mul_f32 v208, s76, v208
v_mul_f32 v209, s76, v209
v_mfma_f32_16x16x32_bf16 v[116:119], a[176:179], v[76:79], v[116:119]
s_waitcnt lgkmcnt(0)
s_barrier
v_mfma_f32_16x16x32_bf16 v[152:155], a[180:183], v[76:79], v[152:155]
v_mul_f32 v210, s76, v210
v_mul_f32 v211, s76, v211
v_mfma_f32_16x16x32_bf16 v[188:191], a[184:187], v[76:79], v[188:191]
v_cvt_pk_bf16_f32 v208, v208, v209
v_cvt_pk_bf16_f32 v209, v210, v211
v_mfma_f32_16x16x32_bf16 v[224:227], a[188:191], v[76:79], v[224:227]
v_mul_f32 v104, s76, v104
s_waitcnt lgkmcnt(2)
v_mfma_f32_16x16x32_bf16 v[120:123], a[160:163], v[80:83], v[120:123]
v_mul_f32 v105, s76, v105
v_mul_f32 v106, s76, v106
v_mfma_f32_16x16x32_bf16 v[156:159], a[164:167], v[80:83], v[156:159]
v_mul_f32 v107, s76, v107
v_cvt_pk_bf16_f32 v104, v104, v105
v_mfma_f32_16x16x32_bf16 v[192:195], a[168:171], v[80:83], v[192:195]
v_cvt_pk_bf16_f32 v105, v106, v107
v_mul_f32 v140, s76, v140
v_mfma_f32_16x16x32_bf16 v[228:231], a[172:175], v[80:83], v[228:231]
v_mul_f32 v141, s76, v141
v_mul_f32 v142, s76, v142
v_mfma_f32_16x16x32_bf16 v[120:123], a[176:179], v[84:87], v[120:123]
v_mul_f32 v143, s76, v143
v_cvt_pk_bf16_f32 v140, v140, v141
v_mfma_f32_16x16x32_bf16 v[156:159], a[180:183], v[84:87], v[156:159]
v_cvt_pk_bf16_f32 v141, v142, v143
v_mul_f32 v176, s76, v176
v_mfma_f32_16x16x32_bf16 v[192:195], a[184:187], v[84:87], v[192:195]
v_mul_f32 v177, s76, v177
v_mul_f32 v178, s76, v178
v_mfma_f32_16x16x32_bf16 v[228:231], a[188:191], v[84:87], v[228:231]
v_mul_f32 v179, s76, v179
s_waitcnt lgkmcnt(0)
v_mfma_f32_16x16x32_bf16 v[124:127], a[160:163], v[88:91], v[124:127]
v_cvt_pk_bf16_f32 v176, v176, v177
v_cvt_pk_bf16_f32 v177, v178, v179
v_mfma_f32_16x16x32_bf16 v[160:163], a[164:167], v[88:91], v[160:163]
v_mul_f32 v212, s76, v212
v_mul_f32 v213, s76, v213
v_mfma_f32_16x16x32_bf16 v[196:199], a[168:171], v[88:91], v[196:199]
v_mul_f32 v214, s76, v214
v_mul_f32 v215, s76, v215
v_mfma_f32_16x16x32_bf16 v[232:235], a[172:175], v[88:91], v[232:235]
v_cvt_pk_bf16_f32 v212, v212, v213
v_cvt_pk_bf16_f32 v213, v214, v215
v_mfma_f32_16x16x32_bf16 v[124:127], a[176:179], v[92:95], v[124:127]
v_mul_f32 v108, s76, v108
v_mul_f32 v109, s76, v109
v_mfma_f32_16x16x32_bf16 v[160:163], a[180:183], v[92:95], v[160:163]
v_mul_f32 v110, s76, v110
v_mul_f32 v111, s76, v111
v_mfma_f32_16x16x32_bf16 v[196:199], a[184:187], v[92:95], v[196:199]
v_cvt_pk_bf16_f32 v108, v108, v109
v_cvt_pk_bf16_f32 v109, v110, v111
v_mfma_f32_16x16x32_bf16 v[232:235], a[188:191], v[92:95], v[232:235]
v_mul_f32 v144, s76, v144
v_mul_f32 v145, s76, v145
v_mfma_f32_16x16x32_bf16 v[128:131], a[160:163], a[248:251], v[128:131]
v_mul_f32 v146, s76, v146
v_mul_f32 v147, s76, v147
v_mfma_f32_16x16x32_bf16 v[164:167], a[164:167], a[248:251], v[164:167]
v_cvt_pk_bf16_f32 v144, v144, v145
v_cvt_pk_bf16_f32 v145, v146, v147
v_mfma_f32_16x16x32_bf16 v[200:203], a[168:171], a[248:251], v[200:203]
v_mul_f32 v180, s76, v180
v_mul_f32 v181, s76, v181
v_mfma_f32_16x16x32_bf16 v[236:239], a[172:175], a[248:251], v[236:239]
v_mul_f32 v182, s76, v182
v_mul_f32 v183, s76, v183
v_mfma_f32_16x16x32_bf16 v[128:131], a[176:179], a[252:255], v[128:131]
v_cvt_pk_bf16_f32 v180, v180, v181
v_cvt_pk_bf16_f32 v181, v182, v183
v_mfma_f32_16x16x32_bf16 v[164:167], a[180:183], a[252:255], v[164:167]
v_mul_f32 v216, s76, v216
v_mul_f32 v217, s76, v217
v_mfma_f32_16x16x32_bf16 v[200:203], a[184:187], a[252:255], v[200:203]
v_mul_f32 v218, s76, v218
v_mul_f32 v219, s76, v219
v_mfma_f32_16x16x32_bf16 v[236:239], a[188:191], a[252:255], v[236:239]
v_cvt_pk_bf16_f32 v216, v216, v217
v_cvt_pk_bf16_f32 v217, v218, v219
ds_write_b64 v9, v[96:97] offset:0
ds_write_b64 v9, v[132:133] offset:32
ds_write_b64 v9, v[168:169] offset:64
ds_write_b64 v9, v[204:205] offset:96
ds_write_b64 v9, v[100:101] offset:8448
ds_write_b64 v9, v[136:137] offset:8480
ds_write_b64 v9, v[172:173] offset:8512
ds_write_b64 v9, v[208:209] offset:8544
ds_write_b64 v9, v[104:105] offset:16896
ds_write_b64 v9, v[140:141] offset:16928
ds_write_b64 v9, v[176:177] offset:16960
ds_write_b64 v9, v[212:213] offset:16992
ds_write_b64 v9, v[108:109] offset:25344
ds_write_b64 v9, v[144:145] offset:25376
ds_write_b64 v9, v[180:181] offset:25408
ds_write_b64 v9, v[216:217] offset:25440
v_pk_mul_f32 v[112:113], v[112:113], s[76:77] op_sel_hi:[1,0]
v_pk_mul_f32 v[114:115], v[114:115], s[76:77] op_sel_hi:[1,0]
v_cvt_pk_bf16_f32 v112, v112, v113
v_cvt_pk_bf16_f32 v113, v114, v115
v_pk_mul_f32 v[148:149], v[148:149], s[76:77] op_sel_hi:[1,0]
v_pk_mul_f32 v[150:151], v[150:151], s[76:77] op_sel_hi:[1,0]
v_cvt_pk_bf16_f32 v148, v148, v149
v_cvt_pk_bf16_f32 v149, v150, v151
v_pk_mul_f32 v[184:185], v[184:185], s[76:77] op_sel_hi:[1,0]
v_pk_mul_f32 v[186:187], v[186:187], s[76:77] op_sel_hi:[1,0]
v_cvt_pk_bf16_f32 v184, v184, v185
v_cvt_pk_bf16_f32 v185, v186, v187
v_pk_mul_f32 v[220:221], v[220:221], s[76:77] op_sel_hi:[1,0]
v_pk_mul_f32 v[222:223], v[222:223], s[76:77] op_sel_hi:[1,0]
v_cvt_pk_bf16_f32 v220, v220, v221
v_cvt_pk_bf16_f32 v221, v222, v223
ds_write_b64 v9, v[112:113] offset:33792
ds_write_b64 v9, v[148:149] offset:33824
ds_write_b64 v9, v[184:185] offset:33856
ds_write_b64 v9, v[220:221] offset:33888
v_pk_mul_f32 v[116:117], v[116:117], s[76:77] op_sel_hi:[1,0]
v_pk_mul_f32 v[118:119], v[118:119], s[76:77] op_sel_hi:[1,0]
v_cvt_pk_bf16_f32 v116, v116, v117
v_cvt_pk_bf16_f32 v117, v118, v119
v_pk_mul_f32 v[152:153], v[152:153], s[76:77] op_sel_hi:[1,0]
v_pk_mul_f32 v[154:155], v[154:155], s[76:77] op_sel_hi:[1,0]
v_cvt_pk_bf16_f32 v152, v152, v153
v_cvt_pk_bf16_f32 v153, v154, v155
v_pk_mul_f32 v[188:189], v[188:189], s[76:77] op_sel_hi:[1,0]
v_pk_mul_f32 v[190:191], v[190:191], s[76:77] op_sel_hi:[1,0]
v_cvt_pk_bf16_f32 v188, v188, v189
v_cvt_pk_bf16_f32 v189, v190, v191
v_pk_mul_f32 v[224:225], v[224:225], s[76:77] op_sel_hi:[1,0]
v_pk_mul_f32 v[226:227], v[226:227], s[76:77] op_sel_hi:[1,0]
v_cvt_pk_bf16_f32 v224, v224, v225
v_cvt_pk_bf16_f32 v225, v226, v227
ds_write_b64 v14, v[116:117] offset:0
ds_write_b64 v14, v[152:153] offset:32
ds_write_b64 v14, v[188:189] offset:64
ds_write_b64 v14, v[224:225] offset:96
v_pk_mul_f32 v[120:121], v[120:121], s[76:77] op_sel_hi:[1,0]
v_pk_mul_f32 v[122:123], v[122:123], s[76:77] op_sel_hi:[1,0]
v_cvt_pk_bf16_f32 v120, v120, v121
v_cvt_pk_bf16_f32 v121, v122, v123
v_pk_mul_f32 v[156:157], v[156:157], s[76:77] op_sel_hi:[1,0]
v_pk_mul_f32 v[158:159], v[158:159], s[76:77] op_sel_hi:[1,0]
v_cvt_pk_bf16_f32 v156, v156, v157
v_cvt_pk_bf16_f32 v157, v158, v159
v_pk_mul_f32 v[192:193], v[192:193], s[76:77] op_sel_hi:[1,0]
v_pk_mul_f32 v[194:195], v[194:195], s[76:77] op_sel_hi:[1,0]
v_cvt_pk_bf16_f32 v192, v192, v193
v_cvt_pk_bf16_f32 v193, v194, v195
v_pk_mul_f32 v[228:229], v[228:229], s[76:77] op_sel_hi:[1,0]
v_pk_mul_f32 v[230:231], v[230:231], s[76:77] op_sel_hi:[1,0]
v_cvt_pk_bf16_f32 v228, v228, v229
v_cvt_pk_bf16_f32 v229, v230, v231
ds_write_b64 v14, v[120:121] offset:8448
ds_write_b64 v14, v[156:157] offset:8480
ds_write_b64 v14, v[192:193] offset:8512
ds_write_b64 v14, v[228:229] offset:8544
v_pk_mul_f32 v[124:125], v[124:125], s[76:77] op_sel_hi:[1,0]
v_pk_mul_f32 v[126:127], v[126:127], s[76:77] op_sel_hi:[1,0]
v_cvt_pk_bf16_f32 v124, v124, v125
v_cvt_pk_bf16_f32 v125, v126, v127
v_pk_mul_f32 v[160:161], v[160:161], s[76:77] op_sel_hi:[1,0]
v_pk_mul_f32 v[162:163], v[162:163], s[76:77] op_sel_hi:[1,0]
v_cvt_pk_bf16_f32 v160, v160, v161
v_cvt_pk_bf16_f32 v161, v162, v163
v_pk_mul_f32 v[196:197], v[196:197], s[76:77] op_sel_hi:[1,0]
v_pk_mul_f32 v[198:199], v[198:199], s[76:77] op_sel_hi:[1,0]
v_cvt_pk_bf16_f32 v196, v196, v197
v_cvt_pk_bf16_f32 v197, v198, v199
v_pk_mul_f32 v[232:233], v[232:233], s[76:77] op_sel_hi:[1,0]
v_pk_mul_f32 v[234:235], v[234:235], s[76:77] op_sel_hi:[1,0]
v_cvt_pk_bf16_f32 v232, v232, v233
v_cvt_pk_bf16_f32 v233, v234, v235
ds_write_b64 v14, v[124:125] offset:16896
ds_write_b64 v14, v[160:161] offset:16928
ds_write_b64 v14, v[196:197] offset:16960
ds_write_b64 v14, v[232:233] offset:16992
v_pk_mul_f32 v[128:129], v[128:129], s[76:77] op_sel_hi:[1,0]
v_pk_mul_f32 v[130:131], v[130:131], s[76:77] op_sel_hi:[1,0]
v_cvt_pk_bf16_f32 v128, v128, v129
v_cvt_pk_bf16_f32 v129, v130, v131
v_pk_mul_f32 v[164:165], v[164:165], s[76:77] op_sel_hi:[1,0]
v_pk_mul_f32 v[166:167], v[166:167], s[76:77] op_sel_hi:[1,0]
v_cvt_pk_bf16_f32 v164, v164, v165
v_cvt_pk_bf16_f32 v165, v166, v167
v_pk_mul_f32 v[200:201], v[200:201], s[76:77] op_sel_hi:[1,0]
v_pk_mul_f32 v[202:203], v[202:203], s[76:77] op_sel_hi:[1,0]
v_cvt_pk_bf16_f32 v200, v200, v201
v_cvt_pk_bf16_f32 v201, v202, v203
v_pk_mul_f32 v[236:237], v[236:237], s[76:77] op_sel_hi:[1,0]
v_pk_mul_f32 v[238:239], v[238:239], s[76:77] op_sel_hi:[1,0]
v_cvt_pk_bf16_f32 v236, v236, v237
v_cvt_pk_bf16_f32 v237, v238, v239
ds_write_b64 v14, v[128:129] offset:25344
ds_write_b64 v14, v[164:165] offset:25376
ds_write_b64 v14, v[200:201] offset:25408
ds_write_b64 v14, v[236:237] offset:25440
s_waitcnt vmcnt(12) lgkmcnt(0)
s_barrier
s_cmp_eq_u32 s30, 3
s_cbranch_scc1 L_loader
v_add_u32 v10, 0, v1
s_nop 0
ds_read_b128 v[20:23], v10 offset:0
ds_read_b128 v[24:27], v10 offset:64
ds_read_b128 v[28:31], v10 offset:128
ds_read_b128 v[32:35], v10 offset:192
ds_read_b128 v[64:67], v19 offset:0
ds_read_b128 v[80:83], v19 offset:8448
ds_read_b128 v[96:99], v19 offset:16896
ds_read_b128 v[68:71], v19 offset:64
ds_read_b128 v[84:87], v19 offset:8512
ds_read_b128 v[100:103], v19 offset:16960
ds_read_b128 v[72:75], v19 offset:128
ds_read_b128 v[88:91], v19 offset:8576
ds_read_b128 v[104:107], v19 offset:17024
s_waitcnt lgkmcnt(6)
v_mfma_f32_16x16x32_bf16 v[208:211], v[20:23], v[64:67], 0
ds_read_b128 v[76:79], v19 offset:192
ds_read_b128 v[92:95], v19 offset:8640
v_mfma_f32_16x16x32_bf16 v[212:215], v[20:23], v[80:83], 0
ds_read_b128 v[108:111], v19 offset:17088
ds_read_b128 a[204:207], v19 offset:256
v_mfma_f32_16x16x32_bf16 v[216:219], v[20:23], v[96:99], 0
ds_read_b128 v[36:39], v10 offset:256
s_waitcnt lgkmcnt(8)
v_mfma_f32_16x16x32_bf16 v[208:211], v[24:27], v[68:71], v[208:211]
ds_read_b128 a[220:223], v19 offset:8704
ds_read_b128 a[236:239], v19 offset:17152
v_mfma_f32_16x16x32_bf16 v[212:215], v[24:27], v[84:87], v[212:215]
ds_read_b128 a[208:211], v19 offset:320
ds_read_b128 a[224:227], v19 offset:8768
v_mfma_f32_16x16x32_bf16 v[216:219], v[24:27], v[100:103], v[216:219]
ds_read_b128 v[40:43], v10 offset:320
s_waitcnt lgkmcnt(10)
v_mfma_f32_16x16x32_bf16 v[208:211], v[28:31], v[72:75], v[208:211]
ds_read_b128 a[240:243], v19 offset:17216
ds_read_b128 a[212:215], v19 offset:384
v_mfma_f32_16x16x32_bf16 v[212:215], v[28:31], v[88:91], v[212:215]
ds_read_b128 a[228:231], v19 offset:8832
ds_read_b128 a[244:247], v19 offset:17280
v_mfma_f32_16x16x32_bf16 v[216:219], v[28:31], v[104:107], v[216:219]
ds_read_b128 v[44:47], v10 offset:384
s_waitcnt lgkmcnt(12)
v_mfma_f32_16x16x32_bf16 v[208:211], v[32:35], v[76:79], v[208:211]
ds_read_b128 a[216:219], v19 offset:448
ds_read_b128 a[232:235], v19 offset:8896
v_mfma_f32_16x16x32_bf16 v[212:215], v[32:35], v[92:95], v[212:215]
ds_read_b128 a[248:251], v19 offset:17344
v_add_u32 v13, 16896, v1
v_mfma_f32_16x16x32_bf16 v[216:219], v[32:35], v[108:111], v[216:219]
ds_read_b128 v[48:51], v10 offset:448
s_waitcnt lgkmcnt(9)
v_mfma_f32_16x16x32_bf16 v[208:211], v[36:39], a[204:207], v[208:211]
v_mov_b32 v232, 0
v_mov_b32 v233, 0
v_mfma_f32_16x16x32_bf16 v[212:215], v[36:39], a[220:223], v[212:215]
v_mov_b32 v234, 0
v_accvgpr_write_b32 a160, 0
v_mfma_f32_16x16x32_bf16 v[216:219], v[36:39], a[236:239], v[216:219]
ds_read_b128 v[20:23], v10 offset:8448
s_waitcnt lgkmcnt(9)
v_mfma_f32_16x16x32_bf16 v[208:211], v[40:43], a[208:211], v[208:211]
v_accvgpr_write_b32 a161, 0
v_accvgpr_write_b32 a162, 0
v_mfma_f32_16x16x32_bf16 v[212:215], v[40:43], a[224:227], v[212:215]
v_accvgpr_write_b32 a163, 0
v_accvgpr_write_b32 a164, 0
v_mfma_f32_16x16x32_bf16 v[216:219], v[40:43], a[240:243], v[216:219]
ds_read_b128 v[24:27], v10 offset:8512
s_waitcnt lgkmcnt(2)
v_mfma_f32_16x16x32_bf16 v[208:211], v[44:47], a[212:215], v[208:211]
v_accvgpr_write_b32 a165, 0
v_accvgpr_write_b32 a166, 0
v_mfma_f32_16x16x32_bf16 v[212:215], v[44:47], a[228:231], v[212:215]
v_accvgpr_write_b32 a167, 0
v_accvgpr_write_b32 a168, 0
v_mfma_f32_16x16x32_bf16 v[216:219], v[44:47], a[244:247], v[216:219]
ds_read_b128 v[28:31], v10 offset:8576
v_mfma_f32_16x16x32_bf16 v[208:211], v[48:51], a[216:219], v[208:211]
v_accvgpr_write_b32 a169, 0
v_accvgpr_write_b32 a170, 0
v_mfma_f32_16x16x32_bf16 v[212:215], v[48:51], a[232:235], v[212:215]
v_accvgpr_write_b32 a171, 0
v_accvgpr_write_b32 a172, 0
v_mfma_f32_16x16x32_bf16 v[216:219], v[48:51], a[248:251], v[216:219]
ds_read_b128 v[32:35], v10 offset:8640
s_waitcnt lgkmcnt(2)
v_mfma_f32_16x16x32_bf16 v[220:223], v[20:23], v[64:67], 0
s_waitcnt vmcnt(0)
s_barrier
ds_read_b128 v[36:39], v10 offset:8704
v_mfma_f32_16x16x32_bf16 v[224:227], v[20:23], v[80:83], 0
v_accvgpr_write_b32 a173, 0
v_accvgpr_write_b32 a174, 0
v_mfma_f32_16x16x32_bf16 v[228:231], v[20:23], v[96:99], 0
v_accvgpr_write_b32 a175, 0
v_accvgpr_write_b32 a176, 0
v_mfma_f32_16x16x32_bf16 v[220:223], v[24:27], v[68:71], v[220:223]
v_accvgpr_write_b32 a177, 0
v_accvgpr_write_b32 a178, 0
v_mfma_f32_16x16x32_bf16 v[224:227], v[24:27], v[84:87], v[224:227]
v_accvgpr_write_b32 a179, 0
v_accvgpr_write_b32 a180, 0
v_mfma_f32_16x16x32_bf16 v[228:231], v[24:27], v[100:103], v[228:231]
ds_read_b128 v[40:43], v10 offset:8768
s_waitcnt lgkmcnt(2)
v_mfma_f32_16x16x32_bf16 v[220:223], v[28:31], v[72:75], v[220:223]
ds_read_b128 v[44:47], v10 offset:8832
v_accvgpr_write_b32 a181, 0
v_mfma_f32_16x16x32_bf16 v[224:227], v[28:31], v[88:91], v[224:227]
v_accvgpr_write_b32 a182, 0
v_accvgpr_write_b32 a183, 0
v_mfma_f32_16x16x32_bf16 v[228:231], v[28:31], v[104:107], v[228:231]
v_accvgpr_write_b32 a184, 0
v_accvgpr_write_b32 a185, 0
v_mfma_f32_16x16x32_bf16 v[220:223], v[32:35], v[76:79], v[220:223]
v_accvgpr_write_b32 a186, 0
v_accvgpr_write_b32 a187, 0
v_mfma_f32_16x16x32_bf16 v[224:227], v[32:35], v[92:95], v[224:227]
v_accvgpr_write_b32 a188, 0
v_accvgpr_write_b32 a189, 0
v_mfma_f32_16x16x32_bf16 v[228:231], v[32:35], v[108:111], v[228:231]
ds_read_b128 v[48:51], v10 offset:8896
s_waitcnt lgkmcnt(2)
v_mfma_f32_16x16x32_bf16 v[220:223], v[36:39], a[204:207], v[220:223]
ds_read_b128 v[20:23], v13 offset:0
v_accvgpr_write_b32 a190, 0
v_mfma_f32_16x16x32_bf16 v[224:227], v[36:39], a[220:223], v[224:227]
v_accvgpr_write_b32 a191, 0
v_mfma_f32_16x16x32_bf16 v[228:231], v[36:39], a[236:239], v[228:231]
v_mfma_f32_16x16x32_bf16 v[220:223], v[40:43], a[208:211], v[220:223]
v_mfma_f32_16x16x32_bf16 v[224:227], v[40:43], a[224:227], v[224:227]
v_mfma_f32_16x16x32_bf16 v[228:231], v[40:43], a[240:243], v[228:231]
ds_read_b128 v[24:27], v13 offset:64
s_waitcnt lgkmcnt(2)
v_mfma_f32_16x16x32_bf16 v[220:223], v[44:47], a[212:215], v[220:223]
ds_read_b128 v[28:31], v13 offset:128
v_mfma_f32_16x16x32_bf16 v[224:227], v[44:47], a[228:231], v[224:227]
v_mfma_f32_16x16x32_bf16 v[228:231], v[44:47], a[244:247], v[228:231]
v_mfma_f32_16x16x32_bf16 v[220:223], v[48:51], a[216:219], v[220:223]
v_mfma_f32_16x16x32_bf16 v[224:227], v[48:51], a[232:235], v[224:227]
v_mfma_f32_16x16x32_bf16 v[228:231], v[48:51], a[248:251], v[228:231]
ds_read_b128 v[32:35], v13 offset:192
s_waitcnt lgkmcnt(2)
s_nop 7
v_max3_f32 v196, v208, v209, v210
v_max3_f32 v196, v196, v211, v220
v_max3_f32 v196, v196, v221, v222
v_max_f32 v196, v196, v223
v_max3_f32 v197, v212, v213, v214
v_max3_f32 v197, v197, v215, v224
v_max3_f32 v197, v197, v225, v226
v_max_f32 v197, v197, v227
v_max3_f32 v198, v216, v217, v218
v_max3_f32 v198, v198, v219, v228
v_max3_f32 v198, v198, v229, v230
v_max_f32 v198, v198, v231
v_mov_b32 v199, v196
v_mov_b32 v200, v197
v_mov_b32 v201, v198
s_nop 1
v_permlane16_swap_b32 v196, v199
v_permlane16_swap_b32 v197, v200
v_permlane16_swap_b32 v198, v201
s_nop 1
v_max_f32 v196, v196, v199
v_max_f32 v197, v197, v200
v_max_f32 v198, v198, v201
v_mov_b32 v199, v196
v_mov_b32 v200, v197
v_mov_b32 v201, v198
s_nop 1
v_permlane32_swap_b32 v196, v199
v_permlane32_swap_b32 v197, v200
v_permlane32_swap_b32 v198, v201
s_nop 1
v_max_f32 v196, v196, v199
v_max_f32 v197, v197, v200
v_max_f32 v198, v198, v201
v_mov_b32 v202, 0x41000000
v_sub_f32 v184, -v196, v202
v_sub_f32 v185, -v196, v202
v_sub_f32 v186, -v196, v202
v_sub_f32 v187, -v196, v202
v_pk_add_f32 v[208:209], v[208:209], v[184:185]
v_pk_add_f32 v[210:211], v[210:211], v[184:185]
v_pk_add_f32 v[220:221], v[220:221], v[184:185]
v_pk_add_f32 v[222:223], v[222:223], v[184:185]
v_sub_f32 v188, -v197, v202
v_sub_f32 v189, -v197, v202
v_sub_f32 v190, -v197, v202
v_sub_f32 v191, -v197, v202
v_pk_add_f32 v[212:213], v[212:213], v[188:189]
v_pk_add_f32 v[214:215], v[214:215], v[188:189]
v_pk_add_f32 v[224:225], v[224:225], v[188:189]
v_pk_add_f32 v[226:227], v[226:227], v[188:189]
v_sub_f32 v192, -v198, v202
v_sub_f32 v193, -v198, v202
v_sub_f32 v194, -v198, v202
v_sub_f32 v195, -v198, v202
v_pk_add_f32 v[216:217], v[216:217], v[192:193]
v_pk_add_f32 v[218:219], v[218:219], v[192:193]
v_pk_add_f32 v[228:229], v[228:229], v[192:193]
v_pk_add_f32 v[230:231], v[230:231], v[192:193]
v_exp_f32 v136, v208
v_exp_f32 v137, v209
v_exp_f32 v138, v210
v_exp_f32 v139, v211
v_exp_f32 v140, v212
v_exp_f32 v141, v213
v_exp_f32 v142, v214
v_exp_f32 v143, v215
v_exp_f32 v144, v216
v_exp_f32 v145, v217
s_nop 0
v_cvt_pk_bf16_f32 v160, v136, v137
v_add_f32 v235, v136, v137
v_cvt_pk_bf16_f32 v161, v138, v139
v_add_f32 v235, v235, v138
v_add_f32 v235, v235, v139
v_cvt_pk_bf16_f32 v164, v140, v141
v_add_f32 v236, v140, v141
v_cvt_pk_bf16_f32 v165, v142, v143
v_add_f32 v236, v236, v142
v_add_f32 v236, v236, v143
v_cvt_pk_bf16_f32 v168, v144, v145
v_add_f32 v237, v144, v145
s_mov_b32 s64, 16896
s_mov_b32 s66, 30
v_mov_b32 v10, v13
.p2align 6
L_pos0:
v_mfma_f32_16x16x32_bf16 v[112:115], v[20:23], v[64:67], v[184:187]
ds_read_b128 v[36:39], v10 offset:256
s_add_u32 s65, s64, 16896
v_mfma_f32_16x16x32_bf16 v[116:119], v[20:23], v[80:83], v[188:191]
s_cmp_eq_u32 s65, 152064
s_cselect_b32 s65, 0, s65
v_mfma_f32_16x16x32_bf16 v[120:123], v[20:23], v[96:99], v[192:195]
v_exp_f32 v146, v218
v_mfma_f32_16x16x32_bf16 v[112:115], v[24:27], v[68:71], v[112:115]
v_exp_f32 v147, v219
v_mfma_f32_16x16x32_bf16 v[116:119], v[24:27], v[84:87], v[116:119]
v_exp_f32 v148, v220
v_mfma_f32_16x16x32_bf16 v[120:123], v[24:27], v[100:103], v[120:123]
ds_read_b128 v[40:43], v10 offset:320
s_waitcnt lgkmcnt(2)
v_mfma_f32_16x16x32_bf16 v[112:115], v[28:31], v[72:75], v[112:115]
ds_read_b128 v[44:47], v10 offset:384
v_add_u32 v11, s65, v2
v_mfma_f32_16x16x32_bf16 v[116:119], v[28:31], v[88:91], v[116:119]
v_exp_f32 v149, v221
v_mfma_f32_16x16x32_bf16 v[120:123], v[28:31], v[104:107], v[120:123]
v_exp_f32 v150, v222
v_mfma_f32_16x16x32_bf16 v[112:115], v[32:35], v[76:79], v[112:115]
v_exp_f32 v151, v223
v_mfma_f32_16x16x32_bf16 v[116:119], v[32:35], v[92:95], v[116:119]
v_exp_f32 v152, v224
v_mfma_f32_16x16x32_bf16 v[120:123], v[32:35], v[108:111], v[120:123]
ds_read_b128 v[48:51], v10 offset:448
s_waitcnt lgkmcnt(2)
v_mfma_f32_16x16x32_bf16 v[112:115], v[36:39], a[204:207], v[112:115]
ds_read_b128 v[20:23], v10 offset:8448
v_add_u32 v12, s65, v3
v_mfma_f32_16x16x32_bf16 v[116:119], v[36:39], a[220:223], v[116:119]
v_exp_f32 v153, v225
v_mfma_f32_16x16x32_bf16 v[120:123], v[36:39], a[236:239], v[120:123]
v_exp_f32 v154, v226
v_mfma_f32_16x16x32_bf16 v[112:115], v[40:43], a[208:211], v[112:115]
v_exp_f32 v155, v227
v_mfma_f32_16x16x32_bf16 v[116:119], v[40:43], a[224:227], v[116:119]
v_exp_f32 v156, v228
v_mfma_f32_16x16x32_bf16 v[120:123], v[40:43], a[240:243], v[120:123]
ds_read_b128 v[24:27], v10 offset:8512
s_waitcnt lgkmcnt(2)
v_mfma_f32_16x16x32_bf16 v[112:115], v[44:47], a[212:215], v[112:115]
ds_read_b128 v[28:31], v10 offset:8576
v_cvt_pk_bf16_f32 v169, v146, v147
v_mfma_f32_16x16x32_bf16 v[116:119], v[44:47], a[228:231], v[116:119]
v_exp_f32 v157, v229
v_mfma_f32_16x16x32_bf16 v[120:123], v[44:47], a[244:247], v[120:123]
v_exp_f32 v158, v230
v_mfma_f32_16x16x32_bf16 v[112:115], v[48:51], a[216:219], v[112:115]
v_exp_f32 v159, v231
v_mfma_f32_16x16x32_bf16 v[116:119], v[48:51], a[232:235], v[116:119]
v_add_f32 v237, v237, v146
v_add_f32 v237, v237, v147
v_mfma_f32_16x16x32_bf16 v[120:123], v[48:51], a[248:251], v[120:123]
ds_read_b128 v[32:35], v10 offset:8640
s_waitcnt lgkmcnt(2)
v_mfma_f32_16x16x32_bf16 v[124:127], v[20:23], v[64:67], v[184:187]
ds_read_b128 v[36:39], v10 offset:8704
v_cvt_pk_bf16_f32 v162, v148, v149
v_mfma_f32_16x16x32_bf16 v[128:131], v[20:23], v[80:83], v[188:191]
v_add_f32 v235, v235, v148
v_add_f32 v235, v235, v149
v_mfma_f32_16x16x32_bf16 v[132:135], v[20:23], v[96:99], v[192:195]
v_cvt_pk_bf16_f32 v163, v150, v151
v_add_f32 v235, v235, v150
v_mfma_f32_16x16x32_bf16 v[124:127], v[24:27], v[68:71], v[124:127]
v_add_f32 v235, v235, v151
v_cvt_pk_bf16_f32 v166, v152, v153
v_mfma_f32_16x16x32_bf16 v[128:131], v[24:27], v[84:87], v[128:131]
v_add_f32 v236, v236, v152
v_add_f32 v236, v236, v153
v_mfma_f32_16x16x32_bf16 v[132:135], v[24:27], v[100:103], v[132:135]
ds_read_b128 v[40:43], v10 offset:8768
s_waitcnt lgkmcnt(2)
v_mfma_f32_16x16x32_bf16 v[124:127], v[28:31], v[72:75], v[124:127]
ds_read_b128 v[44:47], v10 offset:8832
v_cvt_pk_bf16_f32 v167, v154, v155
v_mfma_f32_16x16x32_bf16 v[128:131], v[28:31], v[88:91], v[128:131]
v_add_f32 v236, v236, v154
v_add_f32 v236, v236, v155
v_mfma_f32_16x16x32_bf16 v[132:135], v[28:31], v[104:107], v[132:135]
v_cvt_pk_bf16_f32 v170, v156, v157
v_add_f32 v237, v237, v156
v_mfma_f32_16x16x32_bf16 v[124:127], v[32:35], v[76:79], v[124:127]
v_add_f32 v237, v237, v157
v_cvt_pk_bf16_f32 v171, v158, v159
v_mfma_f32_16x16x32_bf16 v[128:131], v[32:35], v[92:95], v[128:131]
v_add_f32 v237, v237, v158
v_add_f32 v237, v237, v159
v_mfma_f32_16x16x32_bf16 v[132:135], v[32:35], v[108:111], v[132:135]
ds_read_b128 v[48:51], v10 offset:8896
s_waitcnt lgkmcnt(2)
v_mfma_f32_16x16x32_bf16 v[124:127], v[36:39], a[204:207], v[124:127]
ds_read_b64_tr_b16 v[20:21], v11 offset:0
ds_read_b64_tr_b16 v[22:23], v11 offset:8448
v_mfma_f32_16x16x32_bf16 v[128:131], v[36:39], a[220:223], v[128:131]
v_max3_f32 v18, v235, v236, v237
v_cmp_nge_f32 vcc, 2.0, v18
v_mfma_f32_16x16x32_bf16 v[132:135], v[36:39], a[236:239], v[132:135]
s_add_u32 s64, s65, 16896
v_mfma_f32_16x16x32_bf16 v[124:127], v[40:43], a[208:211], v[124:127]
ds_read_b64_tr_b16 v[24:25], v11 offset:32
ds_read_b64_tr_b16 v[26:27], v11 offset:8480
v_mfma_f32_16x16x32_bf16 v[128:131], v[40:43], a[224:227], v[128:131]
s_cmp_eq_u32 s64, 152064
s_cselect_b32 s64, 0, s64
v_mfma_f32_16x16x32_bf16 v[132:135], v[40:43], a[240:243], v[132:135]
v_add_u32 v10, s64, v1
s_waitcnt lgkmcnt(4)
v_mfma_f32_16x16x32_bf16 v[124:127], v[44:47], a[212:215], v[124:127]
ds_read_b64_tr_b16 v[28:29], v11 offset:64
ds_read_b64_tr_b16 v[30:31], v11 offset:8512
v_mfma_f32_16x16x32_bf16 v[128:131], v[44:47], a[228:231], v[128:131]
v_mfma_f32_16x16x32_bf16 v[132:135], v[44:47], a[244:247], v[132:135]
v_mfma_f32_16x16x32_bf16 v[124:127], v[48:51], a[216:219], v[124:127]
ds_read_b64_tr_b16 v[32:33], v11 offset:96
ds_read_b64_tr_b16 v[34:35], v11 offset:8544
v_mfma_f32_16x16x32_bf16 v[128:131], v[48:51], a[232:235], v[128:131]
v_mfma_f32_16x16x32_bf16 v[132:135], v[48:51], a[248:251], v[132:135]
s_waitcnt lgkmcnt(4)
s_cbranch_vccnz L_slow0
L_back0:
v_mfma_f32_16x16x32_bf16 a[0:3], v[20:23], v[160:163], a[0:3]
ds_read_b64_tr_b16 v[36:37], v12 offset:128
ds_read_b64_tr_b16 v[38:39], v12 offset:8576
v_mfma_f32_16x16x32_bf16 a[4:7], v[20:23], v[164:167], a[4:7]
v_add_f32 v232, v232, v235
v_add_f32 v233, v233, v236
v_mfma_f32_16x16x32_bf16 a[8:11], v[20:23], v[168:171], a[8:11]
s_sub_u32 s66, s66, 1
v_add_f32 v234, v234, v237
v_mfma_f32_16x16x32_bf16 a[12:15], v[24:27], v[160:163], a[12:15]
ds_read_b64_tr_b16 v[40:41], v12 offset:160
ds_read_b64_tr_b16 v[42:43], v12 offset:8608
v_mfma_f32_16x16x32_bf16 a[16:19], v[24:27], v[164:167], a[16:19]
v_mfma_f32_16x16x32_bf16 a[20:23], v[24:27], v[168:171], a[20:23]
s_waitcnt lgkmcnt(4)
v_mfma_f32_16x16x32_bf16 a[24:27], v[28:31], v[160:163], a[24:27]
ds_read_b64_tr_b16 v[44:45], v12 offset:192
ds_read_b64_tr_b16 v[46:47], v12 offset:8640
v_mfma_f32_16x16x32_bf16 a[28:31], v[28:31], v[164:167], a[28:31]
v_exp_f32 v136, v112
v_mfma_f32_16x16x32_bf16 a[32:35], v[28:31], v[168:171], a[32:35]
v_exp_f32 v137, v113
v_mfma_f32_16x16x32_bf16 a[36:39], v[32:35], v[160:163], a[36:39]
ds_read_b64_tr_b16 v[48:49], v12 offset:224
ds_read_b64_tr_b16 v[50:51], v12 offset:8672
v_mfma_f32_16x16x32_bf16 a[40:43], v[32:35], v[164:167], a[40:43]
v_exp_f32 v138, v114
v_mfma_f32_16x16x32_bf16 a[44:47], v[32:35], v[168:171], a[44:47]
v_cvt_pk_bf16_f32 v172, v136, v137
s_waitcnt lgkmcnt(4)
v_mfma_f32_16x16x32_bf16 a[48:51], v[36:39], v[160:163], a[48:51]
ds_read_b64_tr_b16 v[20:21], v11 offset:256
ds_read_b64_tr_b16 v[22:23], v11 offset:8704
v_mfma_f32_16x16x32_bf16 a[52:55], v[36:39], v[164:167], a[52:55]
v_exp_f32 v139, v115
v_mfma_f32_16x16x32_bf16 a[56:59], v[36:39], v[168:171], a[56:59]
v_exp_f32 v140, v116
v_mfma_f32_16x16x32_bf16 a[60:63], v[40:43], v[160:163], a[60:63]
ds_read_b64_tr_b16 v[24:25], v11 offset:288
ds_read_b64_tr_b16 v[26:27], v11 offset:8736
v_mfma_f32_16x16x32_bf16 a[64:67], v[40:43], v[164:167], a[64:67]
v_exp_f32 v141, v117
v_mfma_f32_16x16x32_bf16 a[68:71], v[40:43], v[168:171], a[68:71]
v_add_f32 v235, v136, v137
s_waitcnt lgkmcnt(4)
v_mfma_f32_16x16x32_bf16 a[72:75], v[44:47], v[160:163], a[72:75]
ds_read_b64_tr_b16 v[28:29], v11 offset:320
ds_read_b64_tr_b16 v[30:31], v11 offset:8768
v_mfma_f32_16x16x32_bf16 a[76:79], v[44:47], v[164:167], a[76:79]
v_exp_f32 v142, v118
v_mfma_f32_16x16x32_bf16 a[80:83], v[44:47], v[168:171], a[80:83]
v_exp_f32 v143, v119
v_mfma_f32_16x16x32_bf16 a[84:87], v[48:51], v[160:163], a[84:87]
ds_read_b64_tr_b16 v[32:33], v11 offset:352
ds_read_b64_tr_b16 v[34:35], v11 offset:8800
v_mfma_f32_16x16x32_bf16 a[88:91], v[48:51], v[164:167], a[88:91]
v_exp_f32 v144, v120
v_mfma_f32_16x16x32_bf16 a[92:95], v[48:51], v[168:171], a[92:95]
v_cvt_pk_bf16_f32 v173, v138, v139
s_waitcnt lgkmcnt(4)
v_mfma_f32_16x16x32_bf16 a[96:99], v[20:23], v[160:163], a[96:99]
ds_read_b64_tr_b16 v[36:37], v12 offset:384
ds_read_b64_tr_b16 v[38:39], v12 offset:8832
v_mfma_f32_16x16x32_bf16 a[100:103], v[20:23], v[164:167], a[100:103]
v_exp_f32 v145, v121
v_mfma_f32_16x16x32_bf16 a[104:107], v[20:23], v[168:171], a[104:107]
v_add_f32 v235, v235, v138
v_add_f32 v235, v235, v139
v_mfma_f32_16x16x32_bf16 a[108:111], v[24:27], v[160:163], a[108:111]
ds_read_b64_tr_b16 v[40:41], v12 offset:416
ds_read_b64_tr_b16 v[42:43], v12 offset:8864
v_mfma_f32_16x16x32_bf16 a[112:115], v[24:27], v[164:167], a[112:115]
v_cvt_pk_bf16_f32 v176, v140, v141
v_add_f32 v236, v140, v141
v_mfma_f32_16x16x32_bf16 a[116:119], v[24:27], v[168:171], a[116:119]
v_cvt_pk_bf16_f32 v177, v142, v143
s_waitcnt lgkmcnt(4)
v_mfma_f32_16x16x32_bf16 a[120:123], v[28:31], v[160:163], a[120:123]
ds_read_b64_tr_b16 v[44:45], v12 offset:448
ds_read_b64_tr_b16 v[46:47], v12 offset:8896
v_mfma_f32_16x16x32_bf16 a[124:127], v[28:31], v[164:167], a[124:127]
v_add_f32 v236, v236, v142
v_add_f32 v236, v236, v143
v_mfma_f32_16x16x32_bf16 a[128:131], v[28:31], v[168:171], a[128:131]
v_cvt_pk_bf16_f32 v180, v144, v145
v_add_f32 v237, v144, v145
v_mfma_f32_16x16x32_bf16 a[132:135], v[32:35], v[160:163], a[132:135]
ds_read_b64_tr_b16 v[48:49], v12 offset:480
ds_read_b64_tr_b16 v[50:51], v12 offset:8928
v_mfma_f32_16x16x32_bf16 a[136:139], v[32:35], v[164:167], a[136:139]
s_barrier
v_mfma_f32_16x16x32_bf16 a[140:143], v[32:35], v[168:171], a[140:143]
s_waitcnt lgkmcnt(4)
v_mfma_f32_16x16x32_bf16 a[144:147], v[36:39], v[160:163], a[144:147]
ds_read_b128 v[20:23], v10 offset:0
v_mfma_f32_16x16x32_bf16 a[148:151], v[36:39], v[164:167], a[148:151]
v_mfma_f32_16x16x32_bf16 a[152:155], v[36:39], v[168:171], a[152:155]
v_mfma_f32_16x16x32_bf16 a[156:159], v[40:43], v[160:163], a[156:159]
v_mfma_f32_16x16x32_bf16 a[160:163], v[40:43], v[164:167], a[160:163]
v_mfma_f32_16x16x32_bf16 a[164:167], v[40:43], v[168:171], a[164:167]
ds_read_b128 v[24:27], v10 offset:64
s_waitcnt lgkmcnt(2)
v_mfma_f32_16x16x32_bf16 a[168:171], v[44:47], v[160:163], a[168:171]
ds_read_b128 v[28:31], v10 offset:128
v_mfma_f32_16x16x32_bf16 a[172:175], v[44:47], v[164:167], a[172:175]
v_mfma_f32_16x16x32_bf16 a[176:179], v[44:47], v[168:171], a[176:179]
v_mfma_f32_16x16x32_bf16 a[180:183], v[48:51], v[160:163], a[180:183]
v_mfma_f32_16x16x32_bf16 a[184:187], v[48:51], v[164:167], a[184:187]
v_mfma_f32_16x16x32_bf16 a[188:191], v[48:51], v[168:171], a[188:191]
ds_read_b128 v[32:35], v10 offset:192
s_waitcnt lgkmcnt(2)
s_cbranch_scc1 L_exit
L_pos1:
v_mfma_f32_16x16x32_bf16 v[208:211], v[20:23], v[64:67], v[184:187]
ds_read_b128 v[36:39], v10 offset:256
s_add_u32 s65, s64, 16896
v_mfma_f32_16x16x32_bf16 v[212:215], v[20:23], v[80:83], v[188:191]
s_cmp_eq_u32 s65, 152064
s_cselect_b32 s65, 0, s65
v_mfma_f32_16x16x32_bf16 v[216:219], v[20:23], v[96:99], v[192:195]
v_exp_f32 v146, v122
v_mfma_f32_16x16x32_bf16 v[208:211], v[24:27], v[68:71], v[208:211]
v_exp_f32 v147, v123
v_mfma_f32_16x16x32_bf16 v[212:215], v[24:27], v[84:87], v[212:215]
v_exp_f32 v148, v124
v_mfma_f32_16x16x32_bf16 v[216:219], v[24:27], v[100:103], v[216:219]
ds_read_b128 v[40:43], v10 offset:320
s_waitcnt lgkmcnt(2)
v_mfma_f32_16x16x32_bf16 v[208:211], v[28:31], v[72:75], v[208:211]
ds_read_b128 v[44:47], v10 offset:384
v_add_u32 v11, s65, v2
v_mfma_f32_16x16x32_bf16 v[212:215], v[28:31], v[88:91], v[212:215]
v_exp_f32 v149, v125
v_mfma_f32_16x16x32_bf16 v[216:219], v[28:31], v[104:107], v[216:219]
v_exp_f32 v150, v126
v_mfma_f32_16x16x32_bf16 v[208:211], v[32:35], v[76:79], v[208:211]
v_exp_f32 v151, v127
v_mfma_f32_16x16x32_bf16 v[212:215], v[32:35], v[92:95], v[212:215]
v_exp_f32 v152, v128
v_mfma_f32_16x16x32_bf16 v[216:219], v[32:35], v[108:111], v[216:219]
ds_read_b128 v[48:51], v10 offset:448
s_waitcnt lgkmcnt(2)
v_mfma_f32_16x16x32_bf16 v[208:211], v[36:39], a[204:207], v[208:211]
ds_read_b128 v[20:23], v10 offset:8448
v_add_u32 v12, s65, v3
v_mfma_f32_16x16x32_bf16 v[212:215], v[36:39], a[220:223], v[212:215]
v_exp_f32 v153, v129
v_mfma_f32_16x16x32_bf16 v[216:219], v[36:39], a[236:239], v[216:219]
v_exp_f32 v154, v130
v_mfma_f32_16x16x32_bf16 v[208:211], v[40:43], a[208:211], v[208:211]
v_exp_f32 v155, v131
v_mfma_f32_16x16x32_bf16 v[212:215], v[40:43], a[224:227], v[212:215]
v_exp_f32 v156, v132
v_mfma_f32_16x16x32_bf16 v[216:219], v[40:43], a[240:243], v[216:219]
ds_read_b128 v[24:27], v10 offset:8512
s_waitcnt lgkmcnt(2)
v_mfma_f32_16x16x32_bf16 v[208:211], v[44:47], a[212:215], v[208:211]
ds_read_b128 v[28:31], v10 offset:8576
v_cvt_pk_bf16_f32 v181, v146, v147
v_mfma_f32_16x16x32_bf16 v[212:215], v[44:47], a[228:231], v[212:215]
v_exp_f32 v157, v133
v_mfma_f32_16x16x32_bf16 v[216:219], v[44:47], a[244:247], v[216:219]
v_exp_f32 v158, v134
v_mfma_f32_16x16x32_bf16 v[208:211], v[48:51], a[216:219], v[208:211]
v_exp_f32 v159, v135
v_mfma_f32_16x16x32_bf16 v[212:215], v[48:51], a[232:235], v[212:215]
v_add_f32 v237, v237, v146
v_add_f32 v237, v237, v147
v_mfma_f32_16x16x32_bf16 v[216:219], v[48:51], a[248:251], v[216:219]
ds_read_b128 v[32:35], v10 offset:8640
s_waitcnt lgkmcnt(2)
v_mfma_f32_16x16x32_bf16 v[220:223], v[20:23], v[64:67], v[184:187]
ds_read_b128 v[36:39], v10 offset:8704
v_cvt_pk_bf16_f32 v174, v148, v149
v_mfma_f32_16x16x32_bf16 v[224:227], v[20:23], v[80:83], v[188:191]
v_add_f32 v235, v235, v148
v_add_f32 v235, v235, v149
v_mfma_f32_16x16x32_bf16 v[228:231], v[20:23], v[96:99], v[192:195]
v_cvt_pk_bf16_f32 v175, v150, v151
v_add_f32 v235, v235, v150
v_mfma_f32_16x16x32_bf16 v[220:223], v[24:27], v[68:71], v[220:223]
v_add_f32 v235, v235, v151
v_cvt_pk_bf16_f32 v178, v152, v153
v_mfma_f32_16x16x32_bf16 v[224:227], v[24:27], v[84:87], v[224:227]
v_add_f32 v236, v236, v152
v_add_f32 v236, v236, v153
v_mfma_f32_16x16x32_bf16 v[228:231], v[24:27], v[100:103], v[228:231]
ds_read_b128 v[40:43], v10 offset:8768
s_waitcnt lgkmcnt(2)
v_mfma_f32_16x16x32_bf16 v[220:223], v[28:31], v[72:75], v[220:223]
ds_read_b128 v[44:47], v10 offset:8832
v_cvt_pk_bf16_f32 v179, v154, v155
v_mfma_f32_16x16x32_bf16 v[224:227], v[28:31], v[88:91], v[224:227]
v_add_f32 v236, v236, v154
v_add_f32 v236, v236, v155
v_mfma_f32_16x16x32_bf16 v[228:231], v[28:31], v[104:107], v[228:231]
v_cvt_pk_bf16_f32 v182, v156, v157
v_add_f32 v237, v237, v156
v_mfma_f32_16x16x32_bf16 v[220:223], v[32:35], v[76:79], v[220:223]
v_add_f32 v237, v237, v157
v_cvt_pk_bf16_f32 v183, v158, v159
v_mfma_f32_16x16x32_bf16 v[224:227], v[32:35], v[92:95], v[224:227]
v_add_f32 v237, v237, v158
v_add_f32 v237, v237, v159
v_mfma_f32_16x16x32_bf16 v[228:231], v[32:35], v[108:111], v[228:231]
ds_read_b128 v[48:51], v10 offset:8896
s_waitcnt lgkmcnt(2)
v_mfma_f32_16x16x32_bf16 v[220:223], v[36:39], a[204:207], v[220:223]
ds_read_b64_tr_b16 v[20:21], v11 offset:0
ds_read_b64_tr_b16 v[22:23], v11 offset:8448
v_mfma_f32_16x16x32_bf16 v[224:227], v[36:39], a[220:223], v[224:227]
v_max3_f32 v18, v235, v236, v237
v_cmp_nge_f32 vcc, 2.0, v18
v_mfma_f32_16x16x32_bf16 v[228:231], v[36:39], a[236:239], v[228:231]
s_add_u32 s64, s65, 16896
v_mfma_f32_16x16x32_bf16 v[220:223], v[40:43], a[208:211], v[220:223]
ds_read_b64_tr_b16 v[24:25], v11 offset:32
ds_read_b64_tr_b16 v[26:27], v11 offset:8480
v_mfma_f32_16x16x32_bf16 v[224:227], v[40:43], a[224:227], v[224:227]
s_cmp_eq_u32 s64, 152064
s_cselect_b32 s64, 0, s64
v_mfma_f32_16x16x32_bf16 v[228:231], v[40:43], a[240:243], v[228:231]
v_add_u32 v10, s64, v1
s_waitcnt lgkmcnt(4)
v_mfma_f32_16x16x32_bf16 v[220:223], v[44:47], a[212:215], v[220:223]
ds_read_b64_tr_b16 v[28:29], v11 offset:64
ds_read_b64_tr_b16 v[30:31], v11 offset:8512
v_mfma_f32_16x16x32_bf16 v[224:227], v[44:47], a[228:231], v[224:227]
v_mfma_f32_16x16x32_bf16 v[228:231], v[44:47], a[244:247], v[228:231]
v_mfma_f32_16x16x32_bf16 v[220:223], v[48:51], a[216:219], v[220:223]
ds_read_b64_tr_b16 v[32:33], v11 offset:96
ds_read_b64_tr_b16 v[34:35], v11 offset:8544
v_mfma_f32_16x16x32_bf16 v[224:227], v[48:51], a[232:235], v[224:227]
v_mfma_f32_16x16x32_bf16 v[228:231], v[48:51], a[248:251], v[228:231]
s_waitcnt lgkmcnt(4)
s_cbranch_vccnz L_slow1
L_back1:
v_mfma_f32_16x16x32_bf16 a[0:3], v[20:23], v[172:175], a[0:3]
ds_read_b64_tr_b16 v[36:37], v12 offset:128
ds_read_b64_tr_b16 v[38:39], v12 offset:8576
v_mfma_f32_16x16x32_bf16 a[4:7], v[20:23], v[176:179], a[4:7]
v_add_f32 v232, v232, v235
v_add_f32 v233, v233, v236
v_mfma_f32_16x16x32_bf16 a[8:11], v[20:23], v[180:183], a[8:11]
s_sub_u32 s66, s66, 1
v_add_f32 v234, v234, v237
v_mfma_f32_16x16x32_bf16 a[12:15], v[24:27], v[172:175], a[12:15]
ds_read_b64_tr_b16 v[40:41], v12 offset:160
ds_read_b64_tr_b16 v[42:43], v12 offset:8608
v_mfma_f32_16x16x32_bf16 a[16:19], v[24:27], v[176:179], a[16:19]
v_mfma_f32_16x16x32_bf16 a[20:23], v[24:27], v[180:183], a[20:23]
s_waitcnt lgkmcnt(4)
v_mfma_f32_16x16x32_bf16 a[24:27], v[28:31], v[172:175], a[24:27]
ds_read_b64_tr_b16 v[44:45], v12 offset:192
ds_read_b64_tr_b16 v[46:47], v12 offset:8640
v_mfma_f32_16x16x32_bf16 a[28:31], v[28:31], v[176:179], a[28:31]
v_exp_f32 v136, v208
v_mfma_f32_16x16x32_bf16 a[32:35], v[28:31], v[180:183], a[32:35]
v_exp_f32 v137, v209
v_mfma_f32_16x16x32_bf16 a[36:39], v[32:35], v[172:175], a[36:39]
ds_read_b64_tr_b16 v[48:49], v12 offset:224
ds_read_b64_tr_b16 v[50:51], v12 offset:8672
v_mfma_f32_16x16x32_bf16 a[40:43], v[32:35], v[176:179], a[40:43]
v_exp_f32 v138, v210
v_mfma_f32_16x16x32_bf16 a[44:47], v[32:35], v[180:183], a[44:47]
v_cvt_pk_bf16_f32 v160, v136, v137
s_waitcnt lgkmcnt(4)
v_mfma_f32_16x16x32_bf16 a[48:51], v[36:39], v[172:175], a[48:51]
ds_read_b64_tr_b16 v[20:21], v11 offset:256
ds_read_b64_tr_b16 v[22:23], v11 offset:8704
v_mfma_f32_16x16x32_bf16 a[52:55], v[36:39], v[176:179], a[52:55]
v_exp_f32 v139, v211
v_mfma_f32_16x16x32_bf16 a[56:59], v[36:39], v[180:183], a[56:59]
v_exp_f32 v140, v212
v_mfma_f32_16x16x32_bf16 a[60:63], v[40:43], v[172:175], a[60:63]
ds_read_b64_tr_b16 v[24:25], v11 offset:288
ds_read_b64_tr_b16 v[26:27], v11 offset:8736
v_mfma_f32_16x16x32_bf16 a[64:67], v[40:43], v[176:179], a[64:67]
v_exp_f32 v141, v213
v_mfma_f32_16x16x32_bf16 a[68:71], v[40:43], v[180:183], a[68:71]
v_add_f32 v235, v136, v137
s_waitcnt lgkmcnt(4)
v_mfma_f32_16x16x32_bf16 a[72:75], v[44:47], v[172:175], a[72:75]
ds_read_b64_tr_b16 v[28:29], v11 offset:320
ds_read_b64_tr_b16 v[30:31], v11 offset:8768
v_mfma_f32_16x16x32_bf16 a[76:79], v[44:47], v[176:179], a[76:79]
v_exp_f32 v142, v214
v_mfma_f32_16x16x32_bf16 a[80:83], v[44:47], v[180:183], a[80:83]
v_exp_f32 v143, v215
v_mfma_f32_16x16x32_bf16 a[84:87], v[48:51], v[172:175], a[84:87]
ds_read_b64_tr_b16 v[32:33], v11 offset:352
ds_read_b64_tr_b16 v[34:35], v11 offset:8800
v_mfma_f32_16x16x32_bf16 a[88:91], v[48:51], v[176:179], a[88:91]
v_exp_f32 v144, v216
v_mfma_f32_16x16x32_bf16 a[92:95], v[48:51], v[180:183], a[92:95]
v_cvt_pk_bf16_f32 v161, v138, v139
s_waitcnt lgkmcnt(4)
v_mfma_f32_16x16x32_bf16 a[96:99], v[20:23], v[172:175], a[96:99]
ds_read_b64_tr_b16 v[36:37], v12 offset:384
ds_read_b64_tr_b16 v[38:39], v12 offset:8832
v_mfma_f32_16x16x32_bf16 a[100:103], v[20:23], v[176:179], a[100:103]
v_exp_f32 v145, v217
v_mfma_f32_16x16x32_bf16 a[104:107], v[20:23], v[180:183], a[104:107]
v_add_f32 v235, v235, v138
v_add_f32 v235, v235, v139
v_mfma_f32_16x16x32_bf16 a[108:111], v[24:27], v[172:175], a[108:111]
ds_read_b64_tr_b16 v[40:41], v12 offset:416
ds_read_b64_tr_b16 v[42:43], v12 offset:8864
v_mfma_f32_16x16x32_bf16 a[112:115], v[24:27], v[176:179], a[112:115]
v_cvt_pk_bf16_f32 v164, v140, v141
v_add_f32 v236, v140, v141
v_mfma_f32_16x16x32_bf16 a[116:119], v[24:27], v[180:183], a[116:119]
v_cvt_pk_bf16_f32 v165, v142, v143
s_waitcnt lgkmcnt(4)
v_mfma_f32_16x16x32_bf16 a[120:123], v[28:31], v[172:175], a[120:123]
ds_read_b64_tr_b16 v[44:45], v12 offset:448
ds_read_b64_tr_b16 v[46:47], v12 offset:8896
v_mfma_f32_16x16x32_bf16 a[124:127], v[28:31], v[176:179], a[124:127]
v_add_f32 v236, v236, v142
v_add_f32 v236, v236, v143
v_mfma_f32_16x16x32_bf16 a[128:131], v[28:31], v[180:183], a[128:131]
v_cvt_pk_bf16_f32 v168, v144, v145
v_add_f32 v237, v144, v145
v_mfma_f32_16x16x32_bf16 a[132:135], v[32:35], v[172:175], a[132:135]
ds_read_b64_tr_b16 v[48:49], v12 offset:480
ds_read_b64_tr_b16 v[50:51], v12 offset:8928
v_mfma_f32_16x16x32_bf16 a[136:139], v[32:35], v[176:179], a[136:139]
s_barrier
v_mfma_f32_16x16x32_bf16 a[140:143], v[32:35], v[180:183], a[140:143]
s_waitcnt lgkmcnt(4)
v_mfma_f32_16x16x32_bf16 a[144:147], v[36:39], v[172:175], a[144:147]
ds_read_b128 v[20:23], v10 offset:0
v_mfma_f32_16x16x32_bf16 a[148:151], v[36:39], v[176:179], a[148:151]
v_mfma_f32_16x16x32_bf16 a[152:155], v[36:39], v[180:183], a[152:155]
v_mfma_f32_16x16x32_bf16 a[156:159], v[40:43], v[172:175], a[156:159]
v_mfma_f32_16x16x32_bf16 a[160:163], v[40:43], v[176:179], a[160:163]
v_mfma_f32_16x16x32_bf16 a[164:167], v[40:43], v[180:183], a[164:167]
ds_read_b128 v[24:27], v10 offset:64
s_waitcnt lgkmcnt(2)
v_mfma_f32_16x16x32_bf16 a[168:171], v[44:47], v[172:175], a[168:171]
ds_read_b128 v[28:31], v10 offset:128
v_mfma_f32_16x16x32_bf16 a[172:175], v[44:47], v[176:179], a[172:175]
v_mfma_f32_16x16x32_bf16 a[176:179], v[44:47], v[180:183], a[176:179]
v_mfma_f32_16x16x32_bf16 a[180:183], v[48:51], v[172:175], a[180:183]
v_mfma_f32_16x16x32_bf16 a[184:187], v[48:51], v[176:179], a[184:187]
v_mfma_f32_16x16x32_bf16 a[188:191], v[48:51], v[180:183], a[188:191]
ds_read_b128 v[32:35], v10 offset:192
s_waitcnt lgkmcnt(2)
s_branch L_pos0
L_exit:
s_nop 1
v_exp_f32 v146, v122
v_exp_f32 v147, v123
v_exp_f32 v148, v124
v_exp_f32 v149, v125
v_exp_f32 v150, v126
v_exp_f32 v151, v127
v_exp_f32 v152, v128
v_exp_f32 v153, v129
v_exp_f32 v154, v130
v_exp_f32 v155, v131
v_exp_f32 v156, v132
v_exp_f32 v157, v133
v_exp_f32 v158, v134
v_exp_f32 v159, v135
s_nop 0
v_cvt_pk_bf16_f32 v181, v146, v147
v_add_f32 v237, v237, v146
v_add_f32 v237, v237, v147
v_cvt_pk_bf16_f32 v174, v148, v149
v_add_f32 v235, v235, v148
v_add_f32 v235, v235, v149
v_cvt_pk_bf16_f32 v175, v150, v151
v_add_f32 v235, v235, v150
v_add_f32 v235, v235, v151
v_cvt_pk_bf16_f32 v178, v152, v153
v_add_f32 v236, v236, v152
v_add_f32 v236, v236, v153
v_cvt_pk_bf16_f32 v179, v154, v155
v_add_f32 v236, v236, v154
v_add_f32 v236, v236, v155
v_cvt_pk_bf16_f32 v182, v156, v157
v_add_f32 v237, v237, v156
v_add_f32 v237, v237, v157
v_cvt_pk_bf16_f32 v183, v158, v159
v_add_f32 v237, v237, v158
v_add_f32 v237, v237, v159
v_max3_f32 v18, v235, v236, v237
v_cmp_nge_f32 vcc, 2.0, v18
s_waitcnt lgkmcnt(0)
v_add_u32 v11, 0, v2
v_add_u32 v12, 0, v3
s_nop 0
ds_read_b64_tr_b16 v[20:21], v11 offset:0
ds_read_b64_tr_b16 v[22:23], v11 offset:8448
ds_read_b64_tr_b16 v[24:25], v11 offset:32
ds_read_b64_tr_b16 v[26:27], v11 offset:8480
ds_read_b64_tr_b16 v[28:29], v11 offset:64
ds_read_b64_tr_b16 v[30:31], v11 offset:8512
ds_read_b64_tr_b16 v[32:33], v11 offset:96
ds_read_b64_tr_b16 v[34:35], v11 offset:8544
s_cbranch_vccnz L_slowx
L_backx:
s_mul_i32 s35, s30, 3072
s_add_u32 s35, s35, 84480
v_add_u32 v13, s35, v16
v_add_u32 v14, 46080, v13
v_add_f32 v232, v232, v235
v_add_f32 v233, v233, v236
v_add_f32 v234, v234, v237
s_waitcnt lgkmcnt(4)
v_mfma_f32_16x16x32_bf16 a[0:3], v[20:23], v[172:175], a[0:3]
ds_read_b64_tr_b16 v[36:37], v12 offset:128
ds_read_b64_tr_b16 v[38:39], v12 offset:8576
v_mfma_f32_16x16x32_bf16 a[4:7], v[20:23], v[176:179], a[4:7]
v_mfma_f32_16x16x32_bf16 a[8:11], v[20:23], v[180:183], a[8:11]
v_mfma_f32_16x16x32_bf16 a[12:15], v[24:27], v[172:175], a[12:15]
ds_read_b64_tr_b16 v[40:41], v12 offset:160
ds_read_b64_tr_b16 v[42:43], v12 offset:8608
v_mfma_f32_16x16x32_bf16 a[16:19], v[24:27], v[176:179], a[16:19]
v_mfma_f32_16x16x32_bf16 a[20:23], v[24:27], v[180:183], a[20:23]
s_waitcnt lgkmcnt(4)
v_mfma_f32_16x16x32_bf16 a[24:27], v[28:31], v[172:175], a[24:27]
ds_read_b64_tr_b16 v[44:45], v12 offset:192
ds_read_b64_tr_b16 v[46:47], v12 offset:8640
v_mfma_f32_16x16x32_bf16 a[28:31], v[28:31], v[176:179], a[28:31]
v_mfma_f32_16x16x32_bf16 a[32:35], v[28:31], v[180:183], a[32:35]
v_mfma_f32_16x16x32_bf16 a[36:39], v[32:35], v[172:175], a[36:39]
ds_read_b64_tr_b16 v[48:49], v12 offset:224
ds_read_b64_tr_b16 v[50:51], v12 offset:8672
v_mfma_f32_16x16x32_bf16 a[40:43], v[32:35], v[176:179], a[40:43]
v_accvgpr_read_b32 v64, a0
v_accvgpr_read_b32 v65, a1
v_mfma_f32_16x16x32_bf16 a[44:47], v[32:35], v[180:183], a[44:47]
v_accvgpr_read_b32 v66, a2
s_waitcnt lgkmcnt(4)
v_mfma_f32_16x16x32_bf16 a[48:51], v[36:39], v[172:175], a[48:51]
ds_read_b64_tr_b16 v[20:21], v11 offset:256
ds_read_b64_tr_b16 v[22:23], v11 offset:8704
v_mfma_f32_16x16x32_bf16 a[52:55], v[36:39], v[176:179], a[52:55]
v_accvgpr_read_b32 v67, a3
v_accvgpr_read_b32 v68, a12
v_mfma_f32_16x16x32_bf16 a[56:59], v[36:39], v[180:183], a[56:59]
v_accvgpr_read_b32 v69, a13
v_accvgpr_read_b32 v70, a14
v_mfma_f32_16x16x32_bf16 a[60:63], v[40:43], v[172:175], a[60:63]
ds_read_b64_tr_b16 v[24:25], v11 offset:288
ds_read_b64_tr_b16 v[26:27], v11 offset:8736
v_mfma_f32_16x16x32_bf16 a[64:67], v[40:43], v[176:179], a[64:67]
v_accvgpr_read_b32 v71, a15
v_cvt_pk_bf16_f32 v72, v64, v65
v_mfma_f32_16x16x32_bf16 a[68:71], v[40:43], v[180:183], a[68:71]
v_cvt_pk_bf16_f32 v73, v66, v67
s_waitcnt lgkmcnt(4)
v_mfma_f32_16x16x32_bf16 a[72:75], v[44:47], v[172:175], a[72:75]
ds_read_b64_tr_b16 v[28:29], v11 offset:320
ds_read_b64_tr_b16 v[30:31], v11 offset:8768
v_mfma_f32_16x16x32_bf16 a[76:79], v[44:47], v[176:179], a[76:79]
v_cvt_pk_bf16_f32 v74, v68, v69
v_cvt_pk_bf16_f32 v75, v70, v71
v_mfma_f32_16x16x32_bf16 a[80:83], v[44:47], v[180:183], a[80:83]
ds_write_b128 v13, v[72:75] offset:0
v_accvgpr_read_b32 v76, a4
v_mfma_f32_16x16x32_bf16 a[84:87], v[48:51], v[172:175], a[84:87]
ds_read_b64_tr_b16 v[32:33], v11 offset:352
ds_read_b64_tr_b16 v[34:35], v11 offset:8800
v_mfma_f32_16x16x32_bf16 a[88:91], v[48:51], v[176:179], a[88:91]
v_accvgpr_read_b32 v77, a5
v_accvgpr_read_b32 v78, a6
v_mfma_f32_16x16x32_bf16 a[92:95], v[48:51], v[180:183], a[92:95]
v_accvgpr_read_b32 v79, a7
s_waitcnt lgkmcnt(5)
v_mfma_f32_16x16x32_bf16 a[96:99], v[20:23], v[172:175], a[96:99]
ds_read_b64_tr_b16 v[36:37], v12 offset:384
ds_read_b64_tr_b16 v[38:39], v12 offset:8832
v_mfma_f32_16x16x32_bf16 a[100:103], v[20:23], v[176:179], a[100:103]
v_accvgpr_read_b32 v80, a16
v_accvgpr_read_b32 v81, a17
v_mfma_f32_16x16x32_bf16 a[104:107], v[20:23], v[180:183], a[104:107]
v_accvgpr_read_b32 v82, a18
v_accvgpr_read_b32 v83, a19
v_mfma_f32_16x16x32_bf16 a[108:111], v[24:27], v[172:175], a[108:111]
ds_read_b64_tr_b16 v[40:41], v12 offset:416
ds_read_b64_tr_b16 v[42:43], v12 offset:8864
v_mfma_f32_16x16x32_bf16 a[112:115], v[24:27], v[176:179], a[112:115]
v_cvt_pk_bf16_f32 v84, v76, v77
v_cvt_pk_bf16_f32 v85, v78, v79
v_mfma_f32_16x16x32_bf16 a[116:119], v[24:27], v[180:183], a[116:119]
v_cvt_pk_bf16_f32 v86, v80, v81
s_waitcnt lgkmcnt(4)
v_mfma_f32_16x16x32_bf16 a[120:123], v[28:31], v[172:175], a[120:123]
ds_read_b64_tr_b16 v[44:45], v12 offset:448
ds_read_b64_tr_b16 v[46:47], v12 offset:8896
v_mfma_f32_16x16x32_bf16 a[124:127], v[28:31], v[176:179], a[124:127]
v_cvt_pk_bf16_f32 v87, v82, v83
v_mfma_f32_16x16x32_bf16 a[128:131], v[28:31], v[180:183], a[128:131]
ds_write_b128 v13, v[84:87] offset:1024
v_accvgpr_read_b32 v88, a8
v_mfma_f32_16x16x32_bf16 a[132:135], v[32:35], v[172:175], a[132:135]
ds_read_b64_tr_b16 v[48:49], v12 offset:480
ds_read_b64_tr_b16 v[50:51], v12 offset:8928
v_mfma_f32_16x16x32_bf16 a[136:139], v[32:35], v[176:179], a[136:139]
v_accvgpr_read_b32 v89, a9
v_accvgpr_read_b32 v90, a10
v_mfma_f32_16x16x32_bf16 a[140:143], v[32:35], v[180:183], a[140:143]
v_accvgpr_read_b32 v91, a11
s_waitcnt lgkmcnt(5)
v_mfma_f32_16x16x32_bf16 a[144:147], v[36:39], v[172:175], a[144:147]
v_accvgpr_read_b32 v92, a20
v_accvgpr_read_b32 v93, a21
v_mfma_f32_16x16x32_bf16 a[148:151], v[36:39], v[176:179], a[148:151]
v_accvgpr_read_b32 v94, a22
v_accvgpr_read_b32 v95, a23
v_mfma_f32_16x16x32_bf16 a[152:155], v[36:39], v[180:183], a[152:155]
v_cvt_pk_bf16_f32 v96, v88, v89
v_cvt_pk_bf16_f32 v97, v90, v91
v_mfma_f32_16x16x32_bf16 a[156:159], v[40:43], v[172:175], a[156:159]
v_cvt_pk_bf16_f32 v98, v92, v93
v_cvt_pk_bf16_f32 v99, v94, v95
v_mfma_f32_16x16x32_bf16 a[160:163], v[40:43], v[176:179], a[160:163]
ds_write_b128 v13, v[96:99] offset:2048
v_accvgpr_read_b32 v100, a24
v_mfma_f32_16x16x32_bf16 a[164:167], v[40:43], v[180:183], a[164:167]
v_accvgpr_read_b32 v101, a25
s_waitcnt lgkmcnt(1)
v_mfma_f32_16x16x32_bf16 a[168:171], v[44:47], v[172:175], a[168:171]
v_accvgpr_read_b32 v102, a26
v_accvgpr_read_b32 v103, a27
v_mfma_f32_16x16x32_bf16 a[172:175], v[44:47], v[176:179], a[172:175]
v_accvgpr_read_b32 v104, a36
v_accvgpr_read_b32 v105, a37
v_mfma_f32_16x16x32_bf16 a[176:179], v[44:47], v[180:183], a[176:179]
v_accvgpr_read_b32 v106, a38
v_accvgpr_read_b32 v107, a39
v_mfma_f32_16x16x32_bf16 a[180:183], v[48:51], v[172:175], a[180:183]
v_cvt_pk_bf16_f32 v108, v100, v101
v_cvt_pk_bf16_f32 v109, v102, v103
v_mfma_f32_16x16x32_bf16 a[184:187], v[48:51], v[176:179], a[184:187]
v_cvt_pk_bf16_f32 v110, v104, v105
v_cvt_pk_bf16_f32 v111, v106, v107
v_mfma_f32_16x16x32_bf16 a[188:191], v[48:51], v[180:183], a[188:191]
ds_write_b128 v13, v[108:111] offset:9216
s_nop 7
v_mov_b32 v199, v232
v_mov_b32 v200, v233
v_mov_b32 v201, v234
s_nop 1
v_permlane16_swap_b32 v232, v199
v_permlane16_swap_b32 v233, v200
v_permlane16_swap_b32 v234, v201
s_nop 1
v_add_f32 v232, v232, v199
v_add_f32 v233, v233, v200
v_add_f32 v234, v234, v201
v_mov_b32 v199, v232
v_mov_b32 v200, v233
v_mov_b32 v201, v234
s_nop 1
v_permlane32_swap_b32 v232, v199
v_permlane32_swap_b32 v233, v200
v_permlane32_swap_b32 v234, v201
s_nop 1
v_add_f32 v232, v232, v199
v_add_f32 v233, v233, v200
v_add_f32 v234, v234, v201
v_rcp_f32 v232, v232
v_rcp_f32 v233, v233
v_rcp_f32 v234, v234
s_mul_i32 s35, s30, 768
s_add_u32 s35, s35, 158208
v_lshlrev_b32 v10, 2, v0
v_add_u32 v10, s35, v10
ds_write_b32 v10, v232 offset:0
ds_write_b32 v10, v233 offset:256
ds_write_b32 v10, v234 offset:512
v_accvgpr_read_b32 v64, a28
v_accvgpr_read_b32 v65, a29
v_accvgpr_read_b32 v66, a30
v_accvgpr_read_b32 v67, a31
v_accvgpr_read_b32 v68, a40
v_accvgpr_read_b32 v69, a41
v_accvgpr_read_b32 v70, a42
v_accvgpr_read_b32 v71, a43
v_cvt_pk_bf16_f32 v72, v64, v65
v_cvt_pk_bf16_f32 v73, v66, v67
v_cvt_pk_bf16_f32 v74, v68, v69
v_cvt_pk_bf16_f32 v75, v70, v71
ds_write_b128 v13, v[72:75] offset:10240
v_accvgpr_read_b32 v76, a32
v_accvgpr_read_b32 v77, a33
v_accvgpr_read_b32 v78, a34
v_accvgpr_read_b32 v79, a35
v_accvgpr_read_b32 v80, a44
v_accvgpr_read_b32 v81, a45
v_accvgpr_read_b32 v82, a46
v_accvgpr_read_b32 v83, a47
v_cvt_pk_bf16_f32 v84, v76, v77
v_cvt_pk_bf16_f32 v85, v78, v79
v_cvt_pk_bf16_f32 v86, v80, v81
v_cvt_pk_bf16_f32 v87, v82, v83
ds_write_b128 v13, v[84:87] offset:11264
v_accvgpr_read_b32 v88, a48
v_accvgpr_read_b32 v89, a49
v_accvgpr_read_b32 v90, a50
v_accvgpr_read_b32 v91, a51
v_accvgpr_read_b32 v92, a60
v_accvgpr_read_b32 v93, a61
v_accvgpr_read_b32 v94, a62
v_accvgpr_read_b32 v95, a63
v_cvt_pk_bf16_f32 v96, v88, v89
v_cvt_pk_bf16_f32 v97, v90, v91
v_cvt_pk_bf16_f32 v98, v92, v93
v_cvt_pk_bf16_f32 v99, v94, v95
ds_write_b128 v13, v[96:99] offset:18432
v_accvgpr_read_b32 v100, a52
v_accvgpr_read_b32 v101, a53
v_accvgpr_read_b32 v102, a54
v_accvgpr_read_b32 v103, a55
v_accvgpr_read_b32 v104, a64
v_accvgpr_read_b32 v105, a65
v_accvgpr_read_b32 v106, a66
v_accvgpr_read_b32 v107, a67
v_cvt_pk_bf16_f32 v108, v100, v101
v_cvt_pk_bf16_f32 v109, v102, v103
v_cvt_pk_bf16_f32 v110, v104, v105
v_cvt_pk_bf16_f32 v111, v106, v107
ds_write_b128 v13, v[108:111] offset:19456
v_accvgpr_read_b32 v64, a56
v_accvgpr_read_b32 v65, a57
v_accvgpr_read_b32 v66, a58
v_accvgpr_read_b32 v67, a59
v_accvgpr_read_b32 v68, a68
v_accvgpr_read_b32 v69, a69
v_accvgpr_read_b32 v70, a70
v_accvgpr_read_b32 v71, a71
v_cvt_pk_bf16_f32 v72, v64, v65
v_cvt_pk_bf16_f32 v73, v66, v67
v_cvt_pk_bf16_f32 v74, v68, v69
v_cvt_pk_bf16_f32 v75, v70, v71
ds_write_b128 v13, v[72:75] offset:20480
v_accvgpr_read_b32 v76, a72
v_accvgpr_read_b32 v77, a73
v_accvgpr_read_b32 v78, a74
v_accvgpr_read_b32 v79, a75
v_accvgpr_read_b32 v80, a84
v_accvgpr_read_b32 v81, a85
v_accvgpr_read_b32 v82, a86
v_accvgpr_read_b32 v83, a87
v_cvt_pk_bf16_f32 v84, v76, v77
v_cvt_pk_bf16_f32 v85, v78, v79
v_cvt_pk_bf16_f32 v86, v80, v81
v_cvt_pk_bf16_f32 v87, v82, v83
ds_write_b128 v13, v[84:87] offset:27648
v_accvgpr_read_b32 v88, a76
v_accvgpr_read_b32 v89, a77
v_accvgpr_read_b32 v90, a78
v_accvgpr_read_b32 v91, a79
v_accvgpr_read_b32 v92, a88
v_accvgpr_read_b32 v93, a89
v_accvgpr_read_b32 v94, a90
v_accvgpr_read_b32 v95, a91
v_cvt_pk_bf16_f32 v96, v88, v89
v_cvt_pk_bf16_f32 v97, v90, v91
v_cvt_pk_bf16_f32 v98, v92, v93
v_cvt_pk_bf16_f32 v99, v94, v95
ds_write_b128 v13, v[96:99] offset:28672
v_accvgpr_read_b32 v100, a80
v_accvgpr_read_b32 v101, a81
v_accvgpr_read_b32 v102, a82
v_accvgpr_read_b32 v103, a83
v_accvgpr_read_b32 v104, a92
v_accvgpr_read_b32 v105, a93
v_accvgpr_read_b32 v106, a94
v_accvgpr_read_b32 v107, a95
v_cvt_pk_bf16_f32 v108, v100, v101
v_cvt_pk_bf16_f32 v109, v102, v103
v_cvt_pk_bf16_f32 v110, v104, v105
v_cvt_pk_bf16_f32 v111, v106, v107
ds_write_b128 v13, v[108:111] offset:29696
v_accvgpr_read_b32 v64, a96
v_accvgpr_read_b32 v65, a97
v_accvgpr_read_b32 v66, a98
v_accvgpr_read_b32 v67, a99
v_accvgpr_read_b32 v68, a108
v_accvgpr_read_b32 v69, a109
v_accvgpr_read_b32 v70, a110
v_accvgpr_read_b32 v71, a111
v_cvt_pk_bf16_f32 v72, v64, v65
v_cvt_pk_bf16_f32 v73, v66, v67
v_cvt_pk_bf16_f32 v74, v68, v69
v_cvt_pk_bf16_f32 v75, v70, v71
ds_write_b128 v13, v[72:75] offset:36864
v_accvgpr_read_b32 v76, a100
v_accvgpr_read_b32 v77, a101
v_accvgpr_read_b32 v78, a102
v_accvgpr_read_b32 v79, a103
v_accvgpr_read_b32 v80, a112
v_accvgpr_read_b32 v81, a113
v_accvgpr_read_b32 v82, a114
v_accvgpr_read_b32 v83, a115
v_cvt_pk_bf16_f32 v84, v76, v77
v_cvt_pk_bf16_f32 v85, v78, v79
v_cvt_pk_bf16_f32 v86, v80, v81
v_cvt_pk_bf16_f32 v87, v82, v83
ds_write_b128 v13, v[84:87] offset:37888
v_accvgpr_read_b32 v88, a104
v_accvgpr_read_b32 v89, a105
v_accvgpr_read_b32 v90, a106
v_accvgpr_read_b32 v91, a107
v_accvgpr_read_b32 v92, a116
v_accvgpr_read_b32 v93, a117
v_accvgpr_read_b32 v94, a118
v_accvgpr_read_b32 v95, a119
v_cvt_pk_bf16_f32 v96, v88, v89
v_cvt_pk_bf16_f32 v97, v90, v91
v_cvt_pk_bf16_f32 v98, v92, v93
v_cvt_pk_bf16_f32 v99, v94, v95
ds_write_b128 v13, v[96:99] offset:38912
v_accvgpr_read_b32 v100, a120
v_accvgpr_read_b32 v101, a121
v_accvgpr_read_b32 v102, a122
v_accvgpr_read_b32 v103, a123
v_accvgpr_read_b32 v104, a132
v_accvgpr_read_b32 v105, a133
v_accvgpr_read_b32 v106, a134
v_accvgpr_read_b32 v107, a135
v_cvt_pk_bf16_f32 v108, v100, v101
v_cvt_pk_bf16_f32 v109, v102, v103
v_cvt_pk_bf16_f32 v110, v104, v105
v_cvt_pk_bf16_f32 v111, v106, v107
ds_write_b128 v14, v[108:111] offset:0
v_accvgpr_read_b32 v64, a124
v_accvgpr_read_b32 v65, a125
v_accvgpr_read_b32 v66, a126
v_accvgpr_read_b32 v67, a127
v_accvgpr_read_b32 v68, a136
v_accvgpr_read_b32 v69, a137
v_accvgpr_read_b32 v70, a138
v_accvgpr_read_b32 v71, a139
v_cvt_pk_bf16_f32 v72, v64, v65
v_cvt_pk_bf16_f32 v73, v66, v67
v_cvt_pk_bf16_f32 v74, v68, v69
v_cvt_pk_bf16_f32 v75, v70, v71
ds_write_b128 v14, v[72:75] offset:1024
v_accvgpr_read_b32 v76, a128
v_accvgpr_read_b32 v77, a129
v_accvgpr_read_b32 v78, a130
v_accvgpr_read_b32 v79, a131
v_accvgpr_read_b32 v80, a140
v_accvgpr_read_b32 v81, a141
v_accvgpr_read_b32 v82, a142
v_accvgpr_read_b32 v83, a143
v_cvt_pk_bf16_f32 v84, v76, v77
v_cvt_pk_bf16_f32 v85, v78, v79
v_cvt_pk_bf16_f32 v86, v80, v81
v_cvt_pk_bf16_f32 v87, v82, v83
ds_write_b128 v14, v[84:87] offset:2048
v_accvgpr_read_b32 v88, a144
v_accvgpr_read_b32 v89, a145
v_accvgpr_read_b32 v90, a146
v_accvgpr_read_b32 v91, a147
v_accvgpr_read_b32 v92, a156
v_accvgpr_read_b32 v93, a157
v_accvgpr_read_b32 v94, a158
v_accvgpr_read_b32 v95, a159
v_cvt_pk_bf16_f32 v96, v88, v89
v_cvt_pk_bf16_f32 v97, v90, v91
v_cvt_pk_bf16_f32 v98, v92, v93
v_cvt_pk_bf16_f32 v99, v94, v95
ds_write_b128 v14, v[96:99] offset:9216
v_accvgpr_read_b32 v100, a148
v_accvgpr_read_b32 v101, a149
v_accvgpr_read_b32 v102, a150
v_accvgpr_read_b32 v103, a151
v_accvgpr_read_b32 v104, a160
v_accvgpr_read_b32 v105, a161
v_accvgpr_read_b32 v106, a162
v_accvgpr_read_b32 v107, a163
v_cvt_pk_bf16_f32 v108, v100, v101
v_cvt_pk_bf16_f32 v109, v102, v103
v_cvt_pk_bf16_f32 v110, v104, v105
v_cvt_pk_bf16_f32 v111, v106, v107
ds_write_b128 v14, v[108:111] offset:10240
v_accvgpr_read_b32 v64, a152
v_accvgpr_read_b32 v65, a153
v_accvgpr_read_b32 v66, a154
v_accvgpr_read_b32 v67, a155
v_accvgpr_read_b32 v68, a164
v_accvgpr_read_b32 v69, a165
v_accvgpr_read_b32 v70, a166
v_accvgpr_read_b32 v71, a167
v_cvt_pk_bf16_f32 v72, v64, v65
v_cvt_pk_bf16_f32 v73, v66, v67
v_cvt_pk_bf16_f32 v74, v68, v69
v_cvt_pk_bf16_f32 v75, v70, v71
ds_write_b128 v14, v[72:75] offset:11264
v_accvgpr_read_b32 v76, a168
v_accvgpr_read_b32 v77, a169
v_accvgpr_read_b32 v78, a170
v_accvgpr_read_b32 v79, a171
v_accvgpr_read_b32 v80, a180
v_accvgpr_read_b32 v81, a181
v_accvgpr_read_b32 v82, a182
v_accvgpr_read_b32 v83, a183
v_cvt_pk_bf16_f32 v84, v76, v77
v_cvt_pk_bf16_f32 v85, v78, v79
v_cvt_pk_bf16_f32 v86, v80, v81
v_cvt_pk_bf16_f32 v87, v82, v83
ds_write_b128 v14, v[84:87] offset:18432
v_accvgpr_read_b32 v88, a172
v_accvgpr_read_b32 v89, a173
v_accvgpr_read_b32 v90, a174
v_accvgpr_read_b32 v91, a175
v_accvgpr_read_b32 v92, a184
v_accvgpr_read_b32 v93, a185
v_accvgpr_read_b32 v94, a186
v_accvgpr_read_b32 v95, a187
v_cvt_pk_bf16_f32 v96, v88, v89
v_cvt_pk_bf16_f32 v97, v90, v91
v_cvt_pk_bf16_f32 v98, v92, v93
v_cvt_pk_bf16_f32 v99, v94, v95
ds_write_b128 v14, v[96:99] offset:19456
v_accvgpr_read_b32 v100, a176
v_accvgpr_read_b32 v101, a177
v_accvgpr_read_b32 v102, a178
v_accvgpr_read_b32 v103, a179
v_accvgpr_read_b32 v104, a188
v_accvgpr_read_b32 v105, a189
v_accvgpr_read_b32 v106, a190
v_accvgpr_read_b32 v107, a191
v_cvt_pk_bf16_f32 v108, v100, v101
v_cvt_pk_bf16_f32 v109, v102, v103
v_cvt_pk_bf16_f32 v110, v104, v105
v_cvt_pk_bf16_f32 v111, v106, v107
ds_write_b128 v14, v[108:111] offset:20480
s_waitcnt lgkmcnt(0)
L_join:
s_barrier
v_mov_b32 v57, 0
global_load_dword v63, v57, s[18:19] sc1
v_add_u32 v12, 84480, v16
v_add_u32 v13, 130560, v16
v_lshlrev_b32 v60, 2, v0
v_add_u32 v14, 158208, v60
v_lshrrev_b32 v62, 3, v0
v_mul_u32_u24 v62, 2048, v62
v_and_b32 v61, 7, v0
v_lshl_add_u32 v62, v61, 4, v62
s_lshl_b32 s35, s30, 20
v_add_u32 v62, s35, v62
s_mul_i32 s70, s34, 128
v_and_b32 v60, 15, v0
v_mul_u32_u24 v60, 128, v60
s_mul_i32 s35, s34, 2048
v_add_u32 v60, s35, v60
v_add_u32 v10, 16896, v6
ds_read_b32 v168, v14 offset:0
ds_read_b32 v169, v14 offset:256
ds_read_b64_tr_b16 v[96:97], v10 offset:0
ds_read_b64_tr_b16 v[98:99], v10 offset:2112
ds_read_b128 a[0:3], v12 offset:0
ds_read_b128 a[4:7], v12 offset:1024
ds_read_b64_tr_b16 v[100:101], v10 offset:4224
ds_read_b64_tr_b16 v[102:103], v10 offset:6336
ds_read_b128 a[36:39], v12 offset:9216
ds_read_b128 a[40:43], v12 offset:10240
ds_read_b64_tr_b16 v[104:105], v10 offset:8448
ds_read_b64_tr_b16 v[106:107], v10 offset:10560
ds_read_b128 a[72:75], v12 offset:18432
ds_read_b128 a[76:79], v12 offset:19456
ds_read_b64_tr_b16 v[108:109], v10 offset:12672
ds_read_b64_tr_b16 v[110:111], v10 offset:14784
ds_read_b128 a[108:111], v12 offset:27648
ds_read_b128 a[112:115], v12 offset:28672
ds_read_b64_tr_b16 v[112:113], v10 offset:16896
ds_read_b64_tr_b16 v[114:115], v10 offset:19008
ds_read_b128 a[144:147], v12 offset:36864
ds_read_b128 a[148:151], v12 offset:37888
ds_read_b64_tr_b16 v[116:117], v10 offset:21120
ds_read_b64_tr_b16 v[118:119], v10 offset:23232
ds_read_b128 a[180:183], v13 offset:0
ds_read_b128 a[184:187], v13 offset:1024
ds_read_b64_tr_b16 v[120:121], v10 offset:25344
ds_read_b64_tr_b16 v[122:123], v10 offset:27456
ds_read_b128 a[216:219], v13 offset:9216
ds_read_b128 a[220:223], v13 offset:10240
ds_read_b64_tr_b16 v[124:125], v10 offset:29568
ds_read_b64_tr_b16 v[126:127], v10 offset:31680
ds_read_b128 a[252:255], v13 offset:18432
ds_read_b128 v[64:67], v13 offset:19456
v_and_b32 v52, 7, v0
v_lshrrev_b32 v53, 4, v0
v_lshlrev_b32 v53, 1, v53
v_xor_b32 v52, v52, v53
v_lshrrev_b32 v53, 3, v0
v_mul_u32_u24 v53, 896, v53
v_lshl_add_u32 v240, v52, 4, v53
v_add_u32 v241, 6112, v240
v_add_u32 v242, 12224, v240
v_add_u32 v243, 18336, v240
s_mul_i32 s35, s77, 252
v_add_u32 v58, s35, v16
v_add_u32 v59, 64512, v58
v_mov_b32 v52, 0x7ff00000
v_cmp_gt_u32 vcc, 63, v0
s_nop 1
v_cndmask_b32 v58, v52, v58, vcc
v_cndmask_b32 v59, v52, v59, vcc
s_waitcnt lgkmcnt(15)
v_mfma_f32_16x16x32_bf16 v[20:23], v[96:99], a[0:3], 0
ds_read_b128 a[8:11], v12 offset:2048
ds_read_b128 a[12:15], v12 offset:3072
ds_read_b128 a[44:47], v12 offset:11264
v_mfma_f32_16x16x32_bf16 v[24:27], v[96:99], a[4:7], 0
ds_read_b128 a[48:51], v12 offset:12288
ds_read_b128 a[80:83], v12 offset:20480
s_waitcnt lgkmcnt(15)
v_mfma_f32_16x16x32_bf16 v[20:23], v[100:103], a[36:39], v[20:23]
ds_read_b128 a[84:87], v12 offset:21504
ds_read_b128 a[116:119], v12 offset:29696
v_mfma_f32_16x16x32_bf16 v[24:27], v[100:103], a[40:43], v[24:27]
ds_read_b128 a[120:123], v12 offset:30720
s_waitcnt lgkmcnt(15)
v_mfma_f32_16x16x32_bf16 v[20:23], v[104:107], a[72:75], v[20:23]
ds_read_b128 a[152:155], v12 offset:38912
ds_read_b32 v170, v14 offset:512
ds_read_b32 v171, v14 offset:768
v_mfma_f32_16x16x32_bf16 v[24:27], v[104:107], a[76:79], v[24:27]
ds_read_b32 v172, v14 offset:1024
ds_read_b32 v173, v14 offset:1280
s_waitcnt lgkmcnt(15)
v_mfma_f32_16x16x32_bf16 v[20:23], v[108:111], a[108:111], v[20:23]
ds_read_b32 v174, v14 offset:1536
ds_read_b32 v175, v14 offset:1792
ds_read_b32 v176, v14 offset:2048
v_mfma_f32_16x16x32_bf16 v[24:27], v[108:111], a[112:115], v[24:27]
ds_read_b128 a[156:159], v12 offset:39936
ds_read_b128 a[188:191], v13 offset:2048
s_waitcnt lgkmcnt(15)
v_mfma_f32_16x16x32_bf16 v[20:23], v[112:115], a[144:147], v[20:23]
ds_read_b128 a[192:195], v13 offset:3072
ds_read_b128 a[224:227], v13 offset:11264
v_mfma_f32_16x16x32_bf16 v[24:27], v[112:115], a[148:151], v[24:27]
ds_read_b128 a[228:231], v13 offset:12288
s_waitcnt lgkmcnt(15)
v_mfma_f32_16x16x32_bf16 v[20:23], v[116:119], a[180:183], v[20:23]
ds_read_b128 v[68:71], v13 offset:20480
v_mfma_f32_16x16x32_bf16 v[24:27], v[116:119], a[184:187], v[24:27]
ds_read_b128 v[72:75], v13 offset:21504
s_waitcnt lgkmcnt(15)
v_mfma_f32_16x16x32_bf16 v[20:23], v[120:123], a[216:219], v[20:23]
ds_read_b128 a[16:19], v12 offset:4096
v_mfma_f32_16x16x32_bf16 v[24:27], v[120:123], a[220:223], v[24:27]
ds_read_b128 a[20:23], v12 offset:5120
s_waitcnt lgkmcnt(15)
v_mfma_f32_16x16x32_bf16 v[20:23], v[124:127], a[252:255], v[20:23]
ds_read_b128 a[52:55], v12 offset:13312
v_mfma_f32_16x16x32_bf16 v[24:27], v[124:127], v[64:67], v[24:27]
s_barrier
s_waitcnt lgkmcnt(15)
v_mfma_f32_16x16x32_bf16 v[28:31], v[96:99], a[8:11], 0
ds_read_b128 a[56:59], v12 offset:14336
ds_read_b128 a[88:91], v12 offset:22528
v_add_u32 v10, 50688, v6
v_mfma_f32_16x16x32_bf16 v[32:35], v[96:99], a[12:15], 0
ds_read_b128 a[92:95], v12 offset:23552
s_add_u32 m0, s78, 16896
s_add_u32 s37, s38, 256
v_mfma_f32_16x16x32_bf16 v[28:31], v[100:103], a[44:47], v[28:31]
ds_read_b128 a[124:127], v12 offset:31744
v_mfma_f32_16x16x32_bf16 v[32:35], v[100:103], a[48:51], v[32:35]
ds_read_b128 a[128:131], v12 offset:32768
s_waitcnt lgkmcnt(15)
v_mfma_f32_16x16x32_bf16 v[28:31], v[104:107], a[80:83], v[28:31]
ds_read_b128 a[160:163], v12 offset:40960
v_mfma_f32_16x16x32_bf16 v[32:35], v[104:107], a[84:87], v[32:35]
s_add_u32 s36, s67, 0
v_mul_f32 v20, v168, v20
v_mul_f32 v21, v168, v21
v_mfma_f32_16x16x32_bf16 v[28:31], v[108:111], a[116:119], v[28:31]
v_mul_f32 v22, v168, v22
v_mul_f32 v23, v168, v23
v_mul_f32 v24, v169, v24
v_mfma_f32_16x16x32_bf16 v[32:35], v[108:111], a[120:123], v[32:35]
v_mul_f32 v25, v169, v25
v_mul_f32 v26, v169, v26
s_waitcnt lgkmcnt(13)
v_mfma_f32_16x16x32_bf16 v[28:31], v[112:115], a[152:155], v[28:31]
v_mul_f32 v27, v169, v27
v_cvt_pk_bf16_f32 v20, v20, v21
v_cvt_pk_bf16_f32 v21, v22, v23
v_mfma_f32_16x16x32_bf16 v[32:35], v[112:115], a[156:159], v[32:35]
ds_read_b128 a[164:167], v12 offset:41984
v_cvt_pk_bf16_f32 v22, v24, v25
v_cvt_pk_bf16_f32 v23, v26, v27
v_mfma_f32_16x16x32_bf16 v[28:31], v[116:119], a[188:191], v[28:31]
buffer_store_dwordx4 v[20:23], v16, s[60:63], s36 offen sc1
buffer_load_dwordx4 v240, s[56:59], s37 offen offset:0 lds
v_mfma_f32_16x16x32_bf16 v[32:35], v[116:119], a[192:195], v[32:35]
ds_read_b128 a[196:199], v13 offset:4096
ds_read_b128 a[200:203], v13 offset:5120
s_waitcnt lgkmcnt(12)
v_mfma_f32_16x16x32_bf16 v[28:31], v[120:123], a[224:227], v[28:31]
ds_read_b128 a[232:235], v13 offset:13312
ds_read_b128 a[236:239], v13 offset:14336
ds_read_b128 v[76:79], v13 offset:22528
v_mfma_f32_16x16x32_bf16 v[32:35], v[120:123], a[228:231], v[32:35]
ds_read_b128 v[80:83], v13 offset:23552
ds_read_b128 a[24:27], v12 offset:6144
ds_read_b128 a[28:31], v12 offset:7168
v_mfma_f32_16x16x32_bf16 v[28:31], v[124:127], v[68:71], v[28:31]
ds_read_b128 a[60:63], v12 offset:15360
v_mfma_f32_16x16x32_bf16 v[32:35], v[124:127], v[72:75], v[32:35]
ds_read_b128 a[64:67], v12 offset:16384
s_waitcnt lgkmcnt(15)
v_mfma_f32_16x16x32_bf16 v[36:39], v[96:99], a[16:19], 0
ds_read_b128 a[96:99], v12 offset:24576
v_mfma_f32_16x16x32_bf16 v[40:43], v[96:99], a[20:23], 0
ds_read_b128 a[100:103], v12 offset:25600
v_mfma_f32_16x16x32_bf16 v[36:39], v[100:103], a[52:55], v[36:39]
ds_read_b128 a[132:135], v12 offset:33792
v_mfma_f32_16x16x32_bf16 v[40:43], v[100:103], a[56:59], v[40:43]
ds_read_b128 a[136:139], v12 offset:34816
s_waitcnt lgkmcnt(15)
v_mfma_f32_16x16x32_bf16 v[36:39], v[104:107], a[88:91], v[36:39]
ds_read_b128 a[168:171], v12 offset:43008
v_mfma_f32_16x16x32_bf16 v[40:43], v[104:107], a[92:95], v[40:43]
s_add_u32 s36, s67, 1024
v_mul_f32 v28, v170, v28
v_mul_f32 v29, v170, v29
v_mfma_f32_16x16x32_bf16 v[36:39], v[108:111], a[124:127], v[36:39]
v_mul_f32 v30, v170, v30
v_mul_f32 v31, v170, v31
v_mul_f32 v32, v171, v32
v_mfma_f32_16x16x32_bf16 v[40:43], v[108:111], a[128:131], v[40:43]
v_mul_f32 v33, v171, v33
v_mul_f32 v34, v171, v34
s_waitcnt lgkmcnt(13)
v_mfma_f32_16x16x32_bf16 v[36:39], v[112:115], a[160:163], v[36:39]
v_mul_f32 v35, v171, v35
v_cvt_pk_bf16_f32 v28, v28, v29
v_cvt_pk_bf16_f32 v29, v30, v31
v_mfma_f32_16x16x32_bf16 v[40:43], v[112:115], a[164:167], v[40:43]
ds_read_b128 a[172:175], v12 offset:44032
v_cvt_pk_bf16_f32 v30, v32, v33
v_cvt_pk_bf16_f32 v31, v34, v35
v_mfma_f32_16x16x32_bf16 v[36:39], v[116:119], a[196:199], v[36:39]
buffer_store_dwordx4 v[28:31], v16, s[60:63], s36 offen sc1
buffer_load_dwordx4 v241, s[56:59], s37 offen offset:1056 lds
v_mfma_f32_16x16x32_bf16 v[40:43], v[116:119], a[200:203], v[40:43]
ds_read_b128 a[204:207], v13 offset:6144
ds_read_b128 a[208:211], v13 offset:7168
s_waitcnt lgkmcnt(12)
v_mfma_f32_16x16x32_bf16 v[36:39], v[120:123], a[232:235], v[36:39]
ds_read_b128 a[240:243], v13 offset:15360
ds_read_b128 a[244:247], v13 offset:16384
ds_read_b128 v[84:87], v13 offset:24576
v_mfma_f32_16x16x32_bf16 v[40:43], v[120:123], a[236:239], v[40:43]
buffer_load_dwordx4 v242, s[56:59], s37 offen offset:2112 lds
v_mfma_f32_16x16x32_bf16 v[36:39], v[124:127], v[76:79], v[36:39]
ds_read_b128 v[88:91], v13 offset:25600
ds_read_b128 a[32:35], v12 offset:8192
ds_read_b128 a[68:71], v12 offset:17408
v_mfma_f32_16x16x32_bf16 v[40:43], v[124:127], v[80:83], v[40:43]
ds_read_b128 a[104:107], v12 offset:26624
ds_read_b128 a[140:143], v12 offset:35840
s_waitcnt lgkmcnt(15)
v_mfma_f32_16x16x32_bf16 v[20:23], v[96:99], a[24:27], 0
buffer_load_dwordx4 v243, s[56:59], s37 offen offset:3168 lds
s_add_u32 m0, s78, 33792
s_add_u32 s37, s38, 114944
v_mfma_f32_16x16x32_bf16 v[24:27], v[96:99], a[28:31], 0
buffer_load_dwordx4 v240, s[56:59], s37 offen offset:0 lds
v_mfma_f32_16x16x32_bf16 v[20:23], v[100:103], a[60:63], v[20:23]
ds_read_b128 a[176:179], v12 offset:45056
ds_read_b128 a[212:215], v13 offset:8192
ds_read_b128 a[248:251], v13 offset:17408
v_mfma_f32_16x16x32_bf16 v[24:27], v[100:103], a[64:67], v[24:27]
ds_read_b128 v[92:95], v13 offset:26624
ds_read_b64_tr_b16 v[128:129], v10 offset:0
s_waitcnt lgkmcnt(15)
v_mfma_f32_16x16x32_bf16 v[20:23], v[104:107], a[96:99], v[20:23]
buffer_load_dwordx4 v241, s[56:59], s37 offen offset:1056 lds
v_mfma_f32_16x16x32_bf16 v[24:27], v[104:107], a[100:103], v[24:27]
s_add_u32 s36, s67, 2048
v_mul_f32 v36, v172, v36
v_mul_f32 v37, v172, v37
v_mfma_f32_16x16x32_bf16 v[20:23], v[108:111], a[132:135], v[20:23]
v_mul_f32 v38, v172, v38
v_mul_f32 v39, v172, v39
v_mul_f32 v40, v173, v40
v_mfma_f32_16x16x32_bf16 v[24:27], v[108:111], a[136:139], v[24:27]
buffer_load_dwordx4 v242, s[56:59], s37 offen offset:2112 lds
v_mul_f32 v41, v173, v41
s_waitcnt lgkmcnt(13)
v_mfma_f32_16x16x32_bf16 v[20:23], v[112:115], a[168:171], v[20:23]
v_mul_f32 v42, v173, v42
v_mul_f32 v43, v173, v43
v_cvt_pk_bf16_f32 v36, v36, v37
v_mfma_f32_16x16x32_bf16 v[24:27], v[112:115], a[172:175], v[24:27]
v_cvt_pk_bf16_f32 v37, v38, v39
v_cvt_pk_bf16_f32 v38, v40, v41
v_cvt_pk_bf16_f32 v39, v42, v43
v_mfma_f32_16x16x32_bf16 v[20:23], v[116:119], a[204:207], v[20:23]
ds_read_b64_tr_b16 v[130:131], v10 offset:2112
ds_read_b64_tr_b16 v[132:133], v10 offset:4224
ds_read_b64_tr_b16 v[134:135], v10 offset:6336
v_mfma_f32_16x16x32_bf16 v[24:27], v[116:119], a[208:211], v[24:27]
ds_read_b64_tr_b16 v[136:137], v10 offset:8448
ds_read_b64_tr_b16 v[138:139], v10 offset:10560
s_waitcnt lgkmcnt(14)
v_mfma_f32_16x16x32_bf16 v[20:23], v[120:123], a[240:243], v[20:23]
ds_read_b64_tr_b16 v[140:141], v10 offset:12672
ds_read_b64_tr_b16 v[142:143], v10 offset:14784
ds_read_b64_tr_b16 v[144:145], v10 offset:16896
v_mfma_f32_16x16x32_bf16 v[24:27], v[120:123], a[244:247], v[24:27]
ds_read_b64_tr_b16 v[146:147], v10 offset:19008
ds_read_b64_tr_b16 v[148:149], v10 offset:21120
ds_read_b64_tr_b16 v[150:151], v10 offset:23232
v_mfma_f32_16x16x32_bf16 v[20:23], v[124:127], v[84:87], v[20:23]
ds_read_b64_tr_b16 v[152:153], v10 offset:25344
ds_read_b64_tr_b16 v[154:155], v10 offset:27456
v_mfma_f32_16x16x32_bf16 v[24:27], v[124:127], v[88:91], v[24:27]
ds_read_b64_tr_b16 v[156:157], v10 offset:29568
s_waitcnt lgkmcnt(15)
v_mfma_f32_16x16x32_bf16 v[28:31], v[96:99], a[32:35], 0
ds_read_b64_tr_b16 v[158:159], v10 offset:31680
buffer_store_dwordx4 v[36:39], v16, s[60:63], s36 offen sc1
v_mfma_f32_16x16x32_bf16 v[28:31], v[100:103], a[68:71], v[28:31]
buffer_load_dwordx4 v243, s[56:59], s37 offen offset:3168 lds
s_waitcnt lgkmcnt(15)
v_mfma_f32_16x16x32_bf16 v[28:31], v[104:107], a[104:107], v[28:31]
s_waitcnt lgkmcnt(0)
s_barrier
v_mfma_f32_16x16x32_bf16 v[28:31], v[108:111], a[140:143], v[28:31]
s_waitcnt lgkmcnt(15)
v_mfma_f32_16x16x32_bf16 v[28:31], v[112:115], a[176:179], v[28:31]
v_mfma_f32_16x16x32_bf16 v[28:31], v[116:119], a[212:215], v[28:31]
s_waitcnt lgkmcnt(15)
v_mfma_f32_16x16x32_bf16 v[28:31], v[120:123], a[248:251], v[28:31]
v_mfma_f32_16x16x32_bf16 v[28:31], v[124:127], v[92:95], v[28:31]
s_waitcnt lgkmcnt(12)
v_mfma_f32_16x16x32_bf16 v[36:39], v[128:131], a[0:3], 0
s_add_u32 s36, s67, 3072
v_mul_f32 v20, v174, v20
v_mfma_f32_16x16x32_bf16 v[40:43], v[128:131], a[4:7], 0
v_mul_f32 v21, v174, v21
v_mul_f32 v22, v174, v22
v_mfma_f32_16x16x32_bf16 v[36:39], v[132:135], a[36:39], v[36:39]
v_mul_f32 v23, v174, v23
v_mul_f32 v24, v175, v24
v_mfma_f32_16x16x32_bf16 v[40:43], v[132:135], a[40:43], v[40:43]
v_mul_f32 v25, v175, v25
s_waitcnt lgkmcnt(8)
v_mfma_f32_16x16x32_bf16 v[36:39], v[136:139], a[72:75], v[36:39]
v_mul_f32 v26, v175, v26
v_mul_f32 v27, v175, v27
v_mfma_f32_16x16x32_bf16 v[40:43], v[136:139], a[76:79], v[40:43]
v_cvt_pk_bf16_f32 v20, v20, v21
v_cvt_pk_bf16_f32 v21, v22, v23
v_mfma_f32_16x16x32_bf16 v[36:39], v[140:143], a[108:111], v[36:39]
v_cvt_pk_bf16_f32 v22, v24, v25
v_cvt_pk_bf16_f32 v23, v26, v27
v_mfma_f32_16x16x32_bf16 v[40:43], v[140:143], a[112:115], v[40:43]
buffer_store_dwordx4 v[20:23], v16, s[60:63], s36 offen sc1
s_waitcnt lgkmcnt(4)
v_mfma_f32_16x16x32_bf16 v[36:39], v[144:147], a[144:147], v[36:39]
s_add_u32 s35, s67, 4096
v_mul_f32 v28, v176, v28
v_mfma_f32_16x16x32_bf16 v[40:43], v[144:147], a[148:151], v[40:43]
v_mul_f32 v29, v176, v29
v_mul_f32 v30, v176, v30
v_mfma_f32_16x16x32_bf16 v[36:39], v[148:151], a[180:183], v[36:39]
v_mul_f32 v31, v176, v31
v_cvt_pk_bf16_f32 v28, v28, v29
v_mfma_f32_16x16x32_bf16 v[40:43], v[148:151], a[184:187], v[40:43]
v_cvt_pk_bf16_f32 v29, v30, v31
s_waitcnt lgkmcnt(0)
v_mfma_f32_16x16x32_bf16 v[36:39], v[152:155], a[216:219], v[36:39]
buffer_store_dwordx2 v[28:29], v17, s[60:63], s35 offen sc1
s_add_u32 m0, s78, 84480
v_mfma_f32_16x16x32_bf16 v[40:43], v[152:155], a[220:223], v[40:43]
s_add_u32 s37, s38, 384
v_mfma_f32_16x16x32_bf16 v[36:39], v[156:159], a[252:255], v[36:39]
buffer_load_dwordx4 v240, s[56:59], s37 offen offset:0 lds
v_mfma_f32_16x16x32_bf16 v[40:43], v[156:159], v[64:67], v[40:43]
v_mfma_f32_16x16x32_bf16 v[20:23], v[128:131], a[8:11], 0
v_add_u32 v10, 16896, v6
v_mfma_f32_16x16x32_bf16 v[24:27], v[128:131], a[12:15], 0
buffer_load_dwordx4 v241, s[56:59], s37 offen offset:1056 lds
v_mfma_f32_16x16x32_bf16 v[20:23], v[132:135], a[44:47], v[20:23]
v_mfma_f32_16x16x32_bf16 v[24:27], v[132:135], a[48:51], v[24:27]
v_mfma_f32_16x16x32_bf16 v[20:23], v[136:139], a[80:83], v[20:23]
buffer_load_dwordx4 v242, s[56:59], s37 offen offset:2112 lds
v_mfma_f32_16x16x32_bf16 v[24:27], v[136:139], a[84:87], v[24:27]
s_add_u32 s36, s67, 18432
v_mul_f32 v36, v168, v36
v_mfma_f32_16x16x32_bf16 v[20:23], v[140:143], a[116:119], v[20:23]
v_mul_f32 v37, v168, v37
v_mul_f32 v38, v168, v38
v_mfma_f32_16x16x32_bf16 v[24:27], v[140:143], a[120:123], v[24:27]
v_mul_f32 v39, v168, v39
v_mul_f32 v40, v169, v40
v_mfma_f32_16x16x32_bf16 v[20:23], v[144:147], a[152:155], v[20:23]
v_mul_f32 v41, v169, v41
v_mul_f32 v42, v169, v42
v_mfma_f32_16x16x32_bf16 v[24:27], v[144:147], a[156:159], v[24:27]
v_mul_f32 v43, v169, v43
v_cvt_pk_bf16_f32 v36, v36, v37
v_mfma_f32_16x16x32_bf16 v[20:23], v[148:151], a[188:191], v[20:23]
v_cvt_pk_bf16_f32 v37, v38, v39
v_cvt_pk_bf16_f32 v38, v40, v41
v_mfma_f32_16x16x32_bf16 v[24:27], v[148:151], a[192:195], v[24:27]
buffer_load_dwordx4 v243, s[56:59], s37 offen offset:3168 lds
v_cvt_pk_bf16_f32 v39, v42, v43
v_mfma_f32_16x16x32_bf16 v[20:23], v[152:155], a[224:227], v[20:23]
buffer_store_dwordx4 v[36:39], v16, s[60:63], s36 offen sc1
s_add_u32 m0, s78, 101376
v_mfma_f32_16x16x32_bf16 v[24:27], v[152:155], a[228:231], v[24:27]
s_add_u32 s37, s38, 115072
v_mfma_f32_16x16x32_bf16 v[20:23], v[156:159], v[68:71], v[20:23]
buffer_load_dwordx4 v240, s[56:59], s37 offen offset:0 lds
v_mfma_f32_16x16x32_bf16 v[24:27], v[156:159], v[72:75], v[24:27]
v_mfma_f32_16x16x32_bf16 v[28:31], v[128:131], a[16:19], 0
v_mfma_f32_16x16x32_bf16 v[32:35], v[128:131], a[20:23], 0
buffer_load_dwordx4 v241, s[56:59], s37 offen offset:1056 lds
v_mfma_f32_16x16x32_bf16 v[28:31], v[132:135], a[52:55], v[28:31]
v_mfma_f32_16x16x32_bf16 v[32:35], v[132:135], a[56:59], v[32:35]
v_mfma_f32_16x16x32_bf16 v[28:31], v[136:139], a[88:91], v[28:31]
buffer_load_dwordx4 v242, s[56:59], s37 offen offset:2112 lds
v_mfma_f32_16x16x32_bf16 v[32:35], v[136:139], a[92:95], v[32:35]
s_add_u32 s36, s67, 19456
v_mul_f32 v20, v170, v20
v_mfma_f32_16x16x32_bf16 v[28:31], v[140:143], a[124:127], v[28:31]
v_mul_f32 v21, v170, v21
v_mul_f32 v22, v170, v22
v_mfma_f32_16x16x32_bf16 v[32:35], v[140:143], a[128:131], v[32:35]
v_mul_f32 v23, v170, v23
v_mul_f32 v24, v171, v24
v_mfma_f32_16x16x32_bf16 v[28:31], v[144:147], a[160:163], v[28:31]
v_mul_f32 v25, v171, v25
v_mul_f32 v26, v171, v26
v_mfma_f32_16x16x32_bf16 v[32:35], v[144:147], a[164:167], v[32:35]
v_mul_f32 v27, v171, v27
v_cvt_pk_bf16_f32 v20, v20, v21
v_mfma_f32_16x16x32_bf16 v[28:31], v[148:151], a[196:199], v[28:31]
v_cvt_pk_bf16_f32 v21, v22, v23
v_cvt_pk_bf16_f32 v22, v24, v25
v_mfma_f32_16x16x32_bf16 v[32:35], v[148:151], a[200:203], v[32:35]
buffer_load_dwordx4 v243, s[56:59], s37 offen offset:3168 lds
v_cvt_pk_bf16_f32 v23, v26, v27
v_mfma_f32_16x16x32_bf16 v[28:31], v[152:155], a[232:235], v[28:31]
buffer_store_dwordx4 v[20:23], v16, s[60:63], s36 offen sc1
v_mfma_f32_16x16x32_bf16 v[32:35], v[152:155], a[236:239], v[32:35]
v_mfma_f32_16x16x32_bf16 v[28:31], v[156:159], v[76:79], v[28:31]
v_mfma_f32_16x16x32_bf16 v[32:35], v[156:159], v[80:83], v[32:35]
v_mfma_f32_16x16x32_bf16 v[36:39], v[128:131], a[24:27], 0
v_mfma_f32_16x16x32_bf16 v[40:43], v[128:131], a[28:31], 0
v_mfma_f32_16x16x32_bf16 v[36:39], v[132:135], a[60:63], v[36:39]
v_mfma_f32_16x16x32_bf16 v[40:43], v[132:135], a[64:67], v[40:43]
v_mfma_f32_16x16x32_bf16 v[36:39], v[136:139], a[96:99], v[36:39]
v_mfma_f32_16x16x32_bf16 v[40:43], v[136:139], a[100:103], v[40:43]
s_add_u32 s36, s67, 20480
v_mul_f32 v28, v172, v28
v_mfma_f32_16x16x32_bf16 v[36:39], v[140:143], a[132:135], v[36:39]
s_waitcnt vmcnt(12)
s_barrier
v_mfma_f32_16x16x32_bf16 v[40:43], v[140:143], a[136:139], v[40:43]
v_mul_f32 v29, v172, v29
v_mul_f32 v30, v172, v30
v_mfma_f32_16x16x32_bf16 v[36:39], v[144:147], a[168:171], v[36:39]
v_mul_f32 v31, v172, v31
v_mul_f32 v32, v173, v32
v_mfma_f32_16x16x32_bf16 v[40:43], v[144:147], a[172:175], v[40:43]
v_mul_f32 v33, v173, v33
v_mul_f32 v34, v173, v34
v_mfma_f32_16x16x32_bf16 v[36:39], v[148:151], a[204:207], v[36:39]
v_mul_f32 v35, v173, v35
v_cvt_pk_bf16_f32 v28, v28, v29
v_mfma_f32_16x16x32_bf16 v[40:43], v[148:151], a[208:211], v[40:43]
v_cvt_pk_bf16_f32 v29, v30, v31
v_cvt_pk_bf16_f32 v30, v32, v33
v_mfma_f32_16x16x32_bf16 v[36:39], v[152:155], a[240:243], v[36:39]
ds_read_b64_tr_b16 v[96:97], v10 offset:0
v_cvt_pk_bf16_f32 v31, v34, v35
v_mfma_f32_16x16x32_bf16 v[40:43], v[152:155], a[244:247], v[40:43]
buffer_store_dwordx4 v[28:31], v16, s[60:63], s36 offen sc1
v_mfma_f32_16x16x32_bf16 v[36:39], v[156:159], v[84:87], v[36:39]
ds_read_b64_tr_b16 v[98:99], v10 offset:2112
ds_read_b64_tr_b16 v[100:101], v10 offset:4224
ds_read_b64_tr_b16 v[102:103], v10 offset:6336
v_mfma_f32_16x16x32_bf16 v[40:43], v[156:159], v[88:91], v[40:43]
ds_read_b64_tr_b16 v[104:105], v10 offset:8448
ds_read_b64_tr_b16 v[106:107], v10 offset:10560
v_mfma_f32_16x16x32_bf16 v[20:23], v[128:131], a[32:35], 0
ds_read_b64_tr_b16 v[108:109], v10 offset:12672
ds_read_b64_tr_b16 v[110:111], v10 offset:14784
v_mfma_f32_16x16x32_bf16 v[20:23], v[132:135], a[68:71], v[20:23]
ds_read_b64_tr_b16 v[112:113], v10 offset:16896
ds_read_b64_tr_b16 v[114:115], v10 offset:19008
v_mfma_f32_16x16x32_bf16 v[20:23], v[136:139], a[104:107], v[20:23]
ds_read_b64_tr_b16 v[116:117], v10 offset:21120
ds_read_b64_tr_b16 v[118:119], v10 offset:23232
v_mfma_f32_16x16x32_bf16 v[20:23], v[140:143], a[140:143], v[20:23]
ds_read_b64_tr_b16 v[120:121], v10 offset:25344
ds_read_b64_tr_b16 v[122:123], v10 offset:27456
v_mfma_f32_16x16x32_bf16 v[20:23], v[144:147], a[176:179], v[20:23]
ds_read_b64_tr_b16 v[124:125], v10 offset:29568
ds_read_b64_tr_b16 v[126:127], v10 offset:31680
v_mfma_f32_16x16x32_bf16 v[20:23], v[148:151], a[212:215], v[20:23]
v_mfma_f32_16x16x32_bf16 v[20:23], v[152:155], a[248:251], v[20:23]
v_mfma_f32_16x16x32_bf16 v[20:23], v[156:159], v[92:95], v[20:23]
s_waitcnt lgkmcnt(12)
v_mfma_f32_16x16x32_bf16 v[28:31], v[96:99], a[0:3], 0
s_add_u32 s36, s67, 21504
v_mul_f32 v36, v174, v36
v_mfma_f32_16x16x32_bf16 v[32:35], v[96:99], a[4:7], 0
v_mul_f32 v37, v174, v37
v_mul_f32 v38, v174, v38
v_mfma_f32_16x16x32_bf16 v[28:31], v[100:103], a[36:39], v[28:31]
v_mul_f32 v39, v174, v39
v_mul_f32 v40, v175, v40
v_mfma_f32_16x16x32_bf16 v[32:35], v[100:103], a[40:43], v[32:35]
v_mul_f32 v41, v175, v41
s_waitcnt lgkmcnt(8)
v_mfma_f32_16x16x32_bf16 v[28:31], v[104:107], a[72:75], v[28:31]
v_mul_f32 v42, v175, v42
v_mul_f32 v43, v175, v43
v_mfma_f32_16x16x32_bf16 v[32:35], v[104:107], a[76:79], v[32:35]
v_cvt_pk_bf16_f32 v36, v36, v37
v_cvt_pk_bf16_f32 v37, v38, v39
v_mfma_f32_16x16x32_bf16 v[28:31], v[108:111], a[108:111], v[28:31]
v_cvt_pk_bf16_f32 v38, v40, v41
v_cvt_pk_bf16_f32 v39, v42, v43
v_mfma_f32_16x16x32_bf16 v[32:35], v[108:111], a[112:115], v[32:35]
buffer_store_dwordx4 v[36:39], v16, s[60:63], s36 offen sc1
s_waitcnt lgkmcnt(4)
v_mfma_f32_16x16x32_bf16 v[28:31], v[112:115], a[144:147], v[28:31]
s_add_u32 s35, s67, 22528
v_mul_f32 v20, v176, v20
v_mfma_f32_16x16x32_bf16 v[32:35], v[112:115], a[148:151], v[32:35]
v_mul_f32 v21, v176, v21
v_mul_f32 v22, v176, v22
v_mfma_f32_16x16x32_bf16 v[28:31], v[116:119], a[180:183], v[28:31]
v_mul_f32 v23, v176, v23
v_cvt_pk_bf16_f32 v20, v20, v21
v_mfma_f32_16x16x32_bf16 v[32:35], v[116:119], a[184:187], v[32:35]
v_cvt_pk_bf16_f32 v21, v22, v23
s_waitcnt lgkmcnt(0)
v_mfma_f32_16x16x32_bf16 v[28:31], v[120:123], a[216:219], v[28:31]
buffer_store_dwordx2 v[20:21], v17, s[60:63], s35 offen sc1
s_add_u32 m0, s78, 118272
v_mfma_f32_16x16x32_bf16 v[32:35], v[120:123], a[220:223], v[32:35]
s_add_u32 s37, s38, 512
v_mfma_f32_16x16x32_bf16 v[28:31], v[124:127], a[252:255], v[28:31]
buffer_load_dwordx4 v240, s[56:59], s37 offen offset:0 lds
v_mfma_f32_16x16x32_bf16 v[32:35], v[124:127], v[64:67], v[32:35]
v_mfma_f32_16x16x32_bf16 v[36:39], v[96:99], a[8:11], 0
v_add_u32 v10, 84480, v6
v_mfma_f32_16x16x32_bf16 v[40:43], v[96:99], a[12:15], 0
buffer_load_dwordx4 v241, s[56:59], s37 offen offset:1056 lds
v_mfma_f32_16x16x32_bf16 v[36:39], v[100:103], a[44:47], v[36:39]
v_mfma_f32_16x16x32_bf16 v[40:43], v[100:103], a[48:51], v[40:43]
v_mfma_f32_16x16x32_bf16 v[36:39], v[104:107], a[80:83], v[36:39]
buffer_load_dwordx4 v242, s[56:59], s37 offen offset:2112 lds
v_mfma_f32_16x16x32_bf16 v[40:43], v[104:107], a[84:87], v[40:43]
s_add_u32 s36, s67, 36864
v_mul_f32 v28, v168, v28
v_mfma_f32_16x16x32_bf16 v[36:39], v[108:111], a[116:119], v[36:39]
v_mul_f32 v29, v168, v29
v_mul_f32 v30, v168, v30
v_mfma_f32_16x16x32_bf16 v[40:43], v[108:111], a[120:123], v[40:43]
v_mul_f32 v31, v168, v31
v_mul_f32 v32, v169, v32
v_mfma_f32_16x16x32_bf16 v[36:39], v[112:115], a[152:155], v[36:39]
v_mul_f32 v33, v169, v33
v_mul_f32 v34, v169, v34
v_mfma_f32_16x16x32_bf16 v[40:43], v[112:115], a[156:159], v[40:43]
v_mul_f32 v35, v169, v35
v_cvt_pk_bf16_f32 v28, v28, v29
v_mfma_f32_16x16x32_bf16 v[36:39], v[116:119], a[188:191], v[36:39]
v_cvt_pk_bf16_f32 v29, v30, v31
v_cvt_pk_bf16_f32 v30, v32, v33
v_mfma_f32_16x16x32_bf16 v[40:43], v[116:119], a[192:195], v[40:43]
buffer_load_dwordx4 v243, s[56:59], s37 offen offset:3168 lds
v_cvt_pk_bf16_f32 v31, v34, v35
v_mfma_f32_16x16x32_bf16 v[36:39], v[120:123], a[224:227], v[36:39]
buffer_store_dwordx4 v[28:31], v16, s[60:63], s36 offen sc1
s_add_u32 m0, s78, 135168
v_mfma_f32_16x16x32_bf16 v[40:43], v[120:123], a[228:231], v[40:43]
s_add_u32 s37, s38, 115200
v_mfma_f32_16x16x32_bf16 v[36:39], v[124:127], v[68:71], v[36:39]
buffer_load_dwordx4 v240, s[56:59], s37 offen offset:0 lds
v_mfma_f32_16x16x32_bf16 v[40:43], v[124:127], v[72:75], v[40:43]
v_mfma_f32_16x16x32_bf16 v[20:23], v[96:99], a[16:19], 0
v_mfma_f32_16x16x32_bf16 v[24:27], v[96:99], a[20:23], 0
buffer_load_dwordx4 v241, s[56:59], s37 offen offset:1056 lds
v_mfma_f32_16x16x32_bf16 v[20:23], v[100:103], a[52:55], v[20:23]
v_mfma_f32_16x16x32_bf16 v[24:27], v[100:103], a[56:59], v[24:27]
v_mfma_f32_16x16x32_bf16 v[20:23], v[104:107], a[88:91], v[20:23]
buffer_load_dwordx4 v242, s[56:59], s37 offen offset:2112 lds
v_mfma_f32_16x16x32_bf16 v[24:27], v[104:107], a[92:95], v[24:27]
s_add_u32 s36, s67, 37888
v_mul_f32 v36, v170, v36
v_mfma_f32_16x16x32_bf16 v[20:23], v[108:111], a[124:127], v[20:23]
v_mul_f32 v37, v170, v37
v_mul_f32 v38, v170, v38
v_mfma_f32_16x16x32_bf16 v[24:27], v[108:111], a[128:131], v[24:27]
v_mul_f32 v39, v170, v39
v_mul_f32 v40, v171, v40
v_mfma_f32_16x16x32_bf16 v[20:23], v[112:115], a[160:163], v[20:23]
v_mul_f32 v41, v171, v41
v_mul_f32 v42, v171, v42
v_mfma_f32_16x16x32_bf16 v[24:27], v[112:115], a[164:167], v[24:27]
v_mul_f32 v43, v171, v43
v_cvt_pk_bf16_f32 v36, v36, v37
v_mfma_f32_16x16x32_bf16 v[20:23], v[116:119], a[196:199], v[20:23]
v_cvt_pk_bf16_f32 v37, v38, v39
v_cvt_pk_bf16_f32 v38, v40, v41
v_mfma_f32_16x16x32_bf16 v[24:27], v[116:119], a[200:203], v[24:27]
buffer_load_dwordx4 v243, s[56:59], s37 offen offset:3168 lds
v_cvt_pk_bf16_f32 v39, v42, v43
v_mfma_f32_16x16x32_bf16 v[20:23], v[120:123], a[232:235], v[20:23]
buffer_store_dwordx4 v[36:39], v16, s[60:63], s36 offen sc1
v_mfma_f32_16x16x32_bf16 v[24:27], v[120:123], a[236:239], v[24:27]
v_mfma_f32_16x16x32_bf16 v[20:23], v[124:127], v[76:79], v[20:23]
v_mfma_f32_16x16x32_bf16 v[24:27], v[124:127], v[80:83], v[24:27]
v_mfma_f32_16x16x32_bf16 v[28:31], v[96:99], a[24:27], 0
v_mfma_f32_16x16x32_bf16 v[32:35], v[96:99], a[28:31], 0
v_mfma_f32_16x16x32_bf16 v[28:31], v[100:103], a[60:63], v[28:31]
v_mfma_f32_16x16x32_bf16 v[32:35], v[100:103], a[64:67], v[32:35]
v_mfma_f32_16x16x32_bf16 v[28:31], v[104:107], a[96:99], v[28:31]
v_mfma_f32_16x16x32_bf16 v[32:35], v[104:107], a[100:103], v[32:35]
s_add_u32 s36, s67, 38912
v_mul_f32 v20, v172, v20
v_mfma_f32_16x16x32_bf16 v[28:31], v[108:111], a[132:135], v[28:31]
s_waitcnt vmcnt(14)
s_barrier
v_mfma_f32_16x16x32_bf16 v[32:35], v[108:111], a[136:139], v[32:35]
v_mul_f32 v21, v172, v21
v_mul_f32 v22, v172, v22
v_mfma_f32_16x16x32_bf16 v[28:31], v[112:115], a[168:171], v[28:31]
v_mul_f32 v23, v172, v23
v_mul_f32 v24, v173, v24
v_mfma_f32_16x16x32_bf16 v[32:35], v[112:115], a[172:175], v[32:35]
v_mul_f32 v25, v173, v25
v_mul_f32 v26, v173, v26
v_mfma_f32_16x16x32_bf16 v[28:31], v[116:119], a[204:207], v[28:31]
v_mul_f32 v27, v173, v27
v_cvt_pk_bf16_f32 v20, v20, v21
v_mfma_f32_16x16x32_bf16 v[32:35], v[116:119], a[208:211], v[32:35]
v_cvt_pk_bf16_f32 v21, v22, v23
v_cvt_pk_bf16_f32 v22, v24, v25
v_mfma_f32_16x16x32_bf16 v[28:31], v[120:123], a[240:243], v[28:31]
ds_read_b64_tr_b16 v[128:129], v10 offset:0
v_cvt_pk_bf16_f32 v23, v26, v27
v_mfma_f32_16x16x32_bf16 v[32:35], v[120:123], a[244:247], v[32:35]
buffer_store_dwordx4 v[20:23], v16, s[60:63], s36 offen sc1
v_mfma_f32_16x16x32_bf16 v[28:31], v[124:127], v[84:87], v[28:31]
ds_read_b64_tr_b16 v[130:131], v10 offset:2112
ds_read_b64_tr_b16 v[132:133], v10 offset:4224
ds_read_b64_tr_b16 v[134:135], v10 offset:6336
v_mfma_f32_16x16x32_bf16 v[32:35], v[124:127], v[88:91], v[32:35]
ds_read_b64_tr_b16 v[136:137], v10 offset:8448
ds_read_b64_tr_b16 v[138:139], v10 offset:10560
v_mfma_f32_16x16x32_bf16 v[36:39], v[96:99], a[32:35], 0
ds_read_b64_tr_b16 v[140:141], v10 offset:12672
ds_read_b64_tr_b16 v[142:143], v10 offset:14784
v_mfma_f32_16x16x32_bf16 v[36:39], v[100:103], a[68:71], v[36:39]
ds_read_b64_tr_b16 v[144:145], v10 offset:16896
ds_read_b64_tr_b16 v[146:147], v10 offset:19008
v_mfma_f32_16x16x32_bf16 v[36:39], v[104:107], a[104:107], v[36:39]
ds_read_b64_tr_b16 v[148:149], v10 offset:21120
ds_read_b64_tr_b16 v[150:151], v10 offset:23232
v_mfma_f32_16x16x32_bf16 v[36:39], v[108:111], a[140:143], v[36:39]
ds_read_b64_tr_b16 v[152:153], v10 offset:25344
ds_read_b64_tr_b16 v[154:155], v10 offset:27456
v_mfma_f32_16x16x32_bf16 v[36:39], v[112:115], a[176:179], v[36:39]
ds_read_b64_tr_b16 v[156:157], v10 offset:29568
ds_read_b64_tr_b16 v[158:159], v10 offset:31680
v_mfma_f32_16x16x32_bf16 v[36:39], v[116:119], a[212:215], v[36:39]
v_mfma_f32_16x16x32_bf16 v[36:39], v[120:123], a[248:251], v[36:39]
v_mfma_f32_16x16x32_bf16 v[36:39], v[124:127], v[92:95], v[36:39]
s_waitcnt lgkmcnt(12)
v_mfma_f32_16x16x32_bf16 v[20:23], v[128:131], a[0:3], 0
s_add_u32 s36, s67, 39936
v_mul_f32 v28, v174, v28
v_mfma_f32_16x16x32_bf16 v[24:27], v[128:131], a[4:7], 0
v_mul_f32 v29, v174, v29
v_mul_f32 v30, v174, v30
v_mfma_f32_16x16x32_bf16 v[20:23], v[132:135], a[36:39], v[20:23]
v_mul_f32 v31, v174, v31
v_mul_f32 v32, v175, v32
v_mfma_f32_16x16x32_bf16 v[24:27], v[132:135], a[40:43], v[24:27]
v_mul_f32 v33, v175, v33
s_waitcnt lgkmcnt(8)
v_mfma_f32_16x16x32_bf16 v[20:23], v[136:139], a[72:75], v[20:23]
v_mul_f32 v34, v175, v34
v_mul_f32 v35, v175, v35
v_mfma_f32_16x16x32_bf16 v[24:27], v[136:139], a[76:79], v[24:27]
v_cvt_pk_bf16_f32 v28, v28, v29
v_cvt_pk_bf16_f32 v29, v30, v31
v_mfma_f32_16x16x32_bf16 v[20:23], v[140:143], a[108:111], v[20:23]
v_cvt_pk_bf16_f32 v30, v32, v33
v_cvt_pk_bf16_f32 v31, v34, v35
v_mfma_f32_16x16x32_bf16 v[24:27], v[140:143], a[112:115], v[24:27]
buffer_store_dwordx4 v[28:31], v16, s[60:63], s36 offen sc1
s_waitcnt lgkmcnt(4)
v_mfma_f32_16x16x32_bf16 v[20:23], v[144:147], a[144:147], v[20:23]
s_add_u32 s35, s67, 40960
v_mul_f32 v36, v176, v36
v_mfma_f32_16x16x32_bf16 v[24:27], v[144:147], a[148:151], v[24:27]
v_mul_f32 v37, v176, v37
v_mul_f32 v38, v176, v38
v_mfma_f32_16x16x32_bf16 v[20:23], v[148:151], a[180:183], v[20:23]
v_mul_f32 v39, v176, v39
v_cvt_pk_bf16_f32 v36, v36, v37
v_mfma_f32_16x16x32_bf16 v[24:27], v[148:151], a[184:187], v[24:27]
v_cvt_pk_bf16_f32 v37, v38, v39
s_waitcnt lgkmcnt(0)
v_mfma_f32_16x16x32_bf16 v[20:23], v[152:155], a[216:219], v[20:23]
buffer_store_dwordx2 v[36:37], v17, s[60:63], s35 offen sc1
s_add_u32 m0, s78, 50688
v_mfma_f32_16x16x32_bf16 v[24:27], v[152:155], a[220:223], v[24:27]
s_add_u32 s37, s38, 640
v_mfma_f32_16x16x32_bf16 v[20:23], v[156:159], a[252:255], v[20:23]
buffer_load_dwordx4 v240, s[56:59], s37 offen offset:0 lds
v_mfma_f32_16x16x32_bf16 v[24:27], v[156:159], v[64:67], v[24:27]
v_mfma_f32_16x16x32_bf16 v[28:31], v[128:131], a[8:11], 0
v_add_u32 v10, 118272, v6
v_mfma_f32_16x16x32_bf16 v[32:35], v[128:131], a[12:15], 0
buffer_load_dwordx4 v241, s[56:59], s37 offen offset:1056 lds
v_mfma_f32_16x16x32_bf16 v[28:31], v[132:135], a[44:47], v[28:31]
v_mfma_f32_16x16x32_bf16 v[32:35], v[132:135], a[48:51], v[32:35]
v_mfma_f32_16x16x32_bf16 v[28:31], v[136:139], a[80:83], v[28:31]
buffer_load_dwordx4 v242, s[56:59], s37 offen offset:2112 lds
v_mfma_f32_16x16x32_bf16 v[32:35], v[136:139], a[84:87], v[32:35]
s_add_u32 s36, s67, 55296
v_mul_f32 v20, v168, v20
v_mfma_f32_16x16x32_bf16 v[28:31], v[140:143], a[116:119], v[28:31]
v_mul_f32 v21, v168, v21
v_mul_f32 v22, v168, v22
v_mfma_f32_16x16x32_bf16 v[32:35], v[140:143], a[120:123], v[32:35]
v_mul_f32 v23, v168, v23
v_mul_f32 v24, v169, v24
v_mfma_f32_16x16x32_bf16 v[28:31], v[144:147], a[152:155], v[28:31]
v_mul_f32 v25, v169, v25
v_mul_f32 v26, v169, v26
v_mfma_f32_16x16x32_bf16 v[32:35], v[144:147], a[156:159], v[32:35]
v_mul_f32 v27, v169, v27
v_cvt_pk_bf16_f32 v20, v20, v21
v_mfma_f32_16x16x32_bf16 v[28:31], v[148:151], a[188:191], v[28:31]
v_cvt_pk_bf16_f32 v21, v22, v23
v_cvt_pk_bf16_f32 v22, v24, v25
v_mfma_f32_16x16x32_bf16 v[32:35], v[148:151], a[192:195], v[32:35]
buffer_load_dwordx4 v243, s[56:59], s37 offen offset:3168 lds
v_cvt_pk_bf16_f32 v23, v26, v27
v_mfma_f32_16x16x32_bf16 v[28:31], v[152:155], a[224:227], v[28:31]
buffer_store_dwordx4 v[20:23], v16, s[60:63], s36 offen sc1
s_add_u32 m0, s78, 67584
v_mfma_f32_16x16x32_bf16 v[32:35], v[152:155], a[228:231], v[32:35]
s_add_u32 s37, s38, 115328
v_mfma_f32_16x16x32_bf16 v[28:31], v[156:159], v[68:71], v[28:31]
buffer_load_dwordx4 v240, s[56:59], s37 offen offset:0 lds
v_mfma_f32_16x16x32_bf16 v[32:35], v[156:159], v[72:75], v[32:35]
v_mfma_f32_16x16x32_bf16 v[36:39], v[128:131], a[16:19], 0
v_mfma_f32_16x16x32_bf16 v[40:43], v[128:131], a[20:23], 0
buffer_load_dwordx4 v241, s[56:59], s37 offen offset:1056 lds
v_mfma_f32_16x16x32_bf16 v[36:39], v[132:135], a[52:55], v[36:39]
v_mfma_f32_16x16x32_bf16 v[40:43], v[132:135], a[56:59], v[40:43]
v_mfma_f32_16x16x32_bf16 v[36:39], v[136:139], a[88:91], v[36:39]
buffer_load_dwordx4 v242, s[56:59], s37 offen offset:2112 lds
v_mfma_f32_16x16x32_bf16 v[40:43], v[136:139], a[92:95], v[40:43]
s_add_u32 s36, s67, 56320
v_mul_f32 v28, v170, v28
v_mfma_f32_16x16x32_bf16 v[36:39], v[140:143], a[124:127], v[36:39]
v_mul_f32 v29, v170, v29
v_mul_f32 v30, v170, v30
v_mfma_f32_16x16x32_bf16 v[40:43], v[140:143], a[128:131], v[40:43]
v_mul_f32 v31, v170, v31
v_mul_f32 v32, v171, v32
v_mfma_f32_16x16x32_bf16 v[36:39], v[144:147], a[160:163], v[36:39]
v_mul_f32 v33, v171, v33
v_mul_f32 v34, v171, v34
v_mfma_f32_16x16x32_bf16 v[40:43], v[144:147], a[164:167], v[40:43]
v_mul_f32 v35, v171, v35
v_cvt_pk_bf16_f32 v28, v28, v29
v_mfma_f32_16x16x32_bf16 v[36:39], v[148:151], a[196:199], v[36:39]
v_cvt_pk_bf16_f32 v29, v30, v31
v_cvt_pk_bf16_f32 v30, v32, v33
v_mfma_f32_16x16x32_bf16 v[40:43], v[148:151], a[200:203], v[40:43]
buffer_load_dwordx4 v243, s[56:59], s37 offen offset:3168 lds
v_cvt_pk_bf16_f32 v31, v34, v35
v_mfma_f32_16x16x32_bf16 v[36:39], v[152:155], a[232:235], v[36:39]
buffer_store_dwordx4 v[28:31], v16, s[60:63], s36 offen sc1
v_mfma_f32_16x16x32_bf16 v[40:43], v[152:155], a[236:239], v[40:43]
v_mfma_f32_16x16x32_bf16 v[36:39], v[156:159], v[76:79], v[36:39]
v_mfma_f32_16x16x32_bf16 v[40:43], v[156:159], v[80:83], v[40:43]
v_mfma_f32_16x16x32_bf16 v[20:23], v[128:131], a[24:27], 0
v_mfma_f32_16x16x32_bf16 v[24:27], v[128:131], a[28:31], 0
v_mfma_f32_16x16x32_bf16 v[20:23], v[132:135], a[60:63], v[20:23]
v_mfma_f32_16x16x32_bf16 v[24:27], v[132:135], a[64:67], v[24:27]
v_mfma_f32_16x16x32_bf16 v[20:23], v[136:139], a[96:99], v[20:23]
v_mfma_f32_16x16x32_bf16 v[24:27], v[136:139], a[100:103], v[24:27]
s_add_u32 s36, s67, 57344
v_mul_f32 v36, v172, v36
v_mfma_f32_16x16x32_bf16 v[20:23], v[140:143], a[132:135], v[20:23]
s_waitcnt vmcnt(14)
s_barrier
v_mfma_f32_16x16x32_bf16 v[24:27], v[140:143], a[136:139], v[24:27]
v_mul_f32 v37, v172, v37
v_mul_f32 v38, v172, v38
v_mfma_f32_16x16x32_bf16 v[20:23], v[144:147], a[168:171], v[20:23]
v_mul_f32 v39, v172, v39
v_mul_f32 v40, v173, v40
v_mfma_f32_16x16x32_bf16 v[24:27], v[144:147], a[172:175], v[24:27]
v_mul_f32 v41, v173, v41
v_mul_f32 v42, v173, v42
v_mfma_f32_16x16x32_bf16 v[20:23], v[148:151], a[204:207], v[20:23]
v_mul_f32 v43, v173, v43
v_cvt_pk_bf16_f32 v36, v36, v37
v_mfma_f32_16x16x32_bf16 v[24:27], v[148:151], a[208:211], v[24:27]
v_cvt_pk_bf16_f32 v37, v38, v39
v_cvt_pk_bf16_f32 v38, v40, v41
v_mfma_f32_16x16x32_bf16 v[20:23], v[152:155], a[240:243], v[20:23]
ds_read_b64_tr_b16 v[96:97], v10 offset:0
v_cvt_pk_bf16_f32 v39, v42, v43
v_mfma_f32_16x16x32_bf16 v[24:27], v[152:155], a[244:247], v[24:27]
buffer_store_dwordx4 v[36:39], v16, s[60:63], s36 offen sc1
v_mfma_f32_16x16x32_bf16 v[20:23], v[156:159], v[84:87], v[20:23]
ds_read_b64_tr_b16 v[98:99], v10 offset:2112
ds_read_b64_tr_b16 v[100:101], v10 offset:4224
ds_read_b64_tr_b16 v[102:103], v10 offset:6336
v_mfma_f32_16x16x32_bf16 v[24:27], v[156:159], v[88:91], v[24:27]
ds_read_b64_tr_b16 v[104:105], v10 offset:8448
ds_read_b64_tr_b16 v[106:107], v10 offset:10560
v_mfma_f32_16x16x32_bf16 v[28:31], v[128:131], a[32:35], 0
ds_read_b64_tr_b16 v[108:109], v10 offset:12672
ds_read_b64_tr_b16 v[110:111], v10 offset:14784
v_mfma_f32_16x16x32_bf16 v[28:31], v[132:135], a[68:71], v[28:31]
ds_read_b64_tr_b16 v[112:113], v10 offset:16896
ds_read_b64_tr_b16 v[114:115], v10 offset:19008
v_mfma_f32_16x16x32_bf16 v[28:31], v[136:139], a[104:107], v[28:31]
ds_read_b64_tr_b16 v[116:117], v10 offset:21120
ds_read_b64_tr_b16 v[118:119], v10 offset:23232
v_mfma_f32_16x16x32_bf16 v[28:31], v[140:143], a[140:143], v[28:31]
ds_read_b64_tr_b16 v[120:121], v10 offset:25344
ds_read_b64_tr_b16 v[122:123], v10 offset:27456
v_mfma_f32_16x16x32_bf16 v[28:31], v[144:147], a[176:179], v[28:31]
ds_read_b64_tr_b16 v[124:125], v10 offset:29568
ds_read_b64_tr_b16 v[126:127], v10 offset:31680
v_mfma_f32_16x16x32_bf16 v[28:31], v[148:151], a[212:215], v[28:31]
v_mfma_f32_16x16x32_bf16 v[28:31], v[152:155], a[248:251], v[28:31]
v_mfma_f32_16x16x32_bf16 v[28:31], v[156:159], v[92:95], v[28:31]
s_waitcnt lgkmcnt(12)
v_mfma_f32_16x16x32_bf16 v[36:39], v[96:99], a[0:3], 0
s_add_u32 s36, s67, 58368
v_mul_f32 v20, v174, v20
v_mfma_f32_16x16x32_bf16 v[40:43], v[96:99], a[4:7], 0
v_mul_f32 v21, v174, v21
v_mul_f32 v22, v174, v22
v_mfma_f32_16x16x32_bf16 v[36:39], v[100:103], a[36:39], v[36:39]
v_mul_f32 v23, v174, v23
v_mul_f32 v24, v175, v24
v_mfma_f32_16x16x32_bf16 v[40:43], v[100:103], a[40:43], v[40:43]
v_mul_f32 v25, v175, v25
s_waitcnt lgkmcnt(8)
v_mfma_f32_16x16x32_bf16 v[36:39], v[104:107], a[72:75], v[36:39]
v_mul_f32 v26, v175, v26
v_mul_f32 v27, v175, v27
v_mfma_f32_16x16x32_bf16 v[40:43], v[104:107], a[76:79], v[40:43]
v_cvt_pk_bf16_f32 v20, v20, v21
v_cvt_pk_bf16_f32 v21, v22, v23
v_mfma_f32_16x16x32_bf16 v[36:39], v[108:111], a[108:111], v[36:39]
v_cvt_pk_bf16_f32 v22, v24, v25
v_cvt_pk_bf16_f32 v23, v26, v27
v_mfma_f32_16x16x32_bf16 v[40:43], v[108:111], a[112:115], v[40:43]
buffer_store_dwordx4 v[20:23], v16, s[60:63], s36 offen sc1
s_waitcnt lgkmcnt(4)
v_mfma_f32_16x16x32_bf16 v[36:39], v[112:115], a[144:147], v[36:39]
s_add_u32 s35, s67, 59392
v_mul_f32 v28, v176, v28
v_mfma_f32_16x16x32_bf16 v[40:43], v[112:115], a[148:151], v[40:43]
v_mul_f32 v29, v176, v29
v_mul_f32 v30, v176, v30
v_mfma_f32_16x16x32_bf16 v[36:39], v[116:119], a[180:183], v[36:39]
v_mul_f32 v31, v176, v31
v_cvt_pk_bf16_f32 v28, v28, v29
v_mfma_f32_16x16x32_bf16 v[40:43], v[116:119], a[184:187], v[40:43]
v_cvt_pk_bf16_f32 v29, v30, v31
s_waitcnt lgkmcnt(0)
v_mfma_f32_16x16x32_bf16 v[36:39], v[120:123], a[216:219], v[36:39]
buffer_store_dwordx2 v[28:29], v17, s[60:63], s35 offen sc1
s_add_u32 m0, s78, 16896
v_mfma_f32_16x16x32_bf16 v[40:43], v[120:123], a[220:223], v[40:43]
s_add_u32 s37, s38, 768
v_mfma_f32_16x16x32_bf16 v[36:39], v[124:127], a[252:255], v[36:39]
buffer_load_dwordx4 v240, s[56:59], s37 offen offset:0 lds
v_mfma_f32_16x16x32_bf16 v[40:43], v[124:127], v[64:67], v[40:43]
v_mfma_f32_16x16x32_bf16 v[20:23], v[96:99], a[8:11], 0
v_add_u32 v10, 50688, v6
v_mfma_f32_16x16x32_bf16 v[24:27], v[96:99], a[12:15], 0
buffer_load_dwordx4 v241, s[56:59], s37 offen offset:1056 lds
v_mfma_f32_16x16x32_bf16 v[20:23], v[100:103], a[44:47], v[20:23]
v_mfma_f32_16x16x32_bf16 v[24:27], v[100:103], a[48:51], v[24:27]
v_mfma_f32_16x16x32_bf16 v[20:23], v[104:107], a[80:83], v[20:23]
buffer_load_dwordx4 v242, s[56:59], s37 offen offset:2112 lds
v_mfma_f32_16x16x32_bf16 v[24:27], v[104:107], a[84:87], v[24:27]
s_add_u32 s36, s67, 73728
v_mul_f32 v36, v168, v36
v_mfma_f32_16x16x32_bf16 v[20:23], v[108:111], a[116:119], v[20:23]
v_mul_f32 v37, v168, v37
v_mul_f32 v38, v168, v38
v_mfma_f32_16x16x32_bf16 v[24:27], v[108:111], a[120:123], v[24:27]
v_mul_f32 v39, v168, v39
v_mul_f32 v40, v169, v40
v_mfma_f32_16x16x32_bf16 v[20:23], v[112:115], a[152:155], v[20:23]
v_mul_f32 v41, v169, v41
v_mul_f32 v42, v169, v42
v_mfma_f32_16x16x32_bf16 v[24:27], v[112:115], a[156:159], v[24:27]
v_mul_f32 v43, v169, v43
v_cvt_pk_bf16_f32 v36, v36, v37
v_mfma_f32_16x16x32_bf16 v[20:23], v[116:119], a[188:191], v[20:23]
v_cvt_pk_bf16_f32 v37, v38, v39
v_cvt_pk_bf16_f32 v38, v40, v41
v_mfma_f32_16x16x32_bf16 v[24:27], v[116:119], a[192:195], v[24:27]
buffer_load_dwordx4 v243, s[56:59], s37 offen offset:3168 lds
v_cvt_pk_bf16_f32 v39, v42, v43
v_mfma_f32_16x16x32_bf16 v[20:23], v[120:123], a[224:227], v[20:23]
buffer_store_dwordx4 v[36:39], v16, s[60:63], s36 offen sc1
s_add_u32 m0, s78, 33792
v_mfma_f32_16x16x32_bf16 v[24:27], v[120:123], a[228:231], v[24:27]
s_add_u32 s37, s38, 115456
v_mfma_f32_16x16x32_bf16 v[20:23], v[124:127], v[68:71], v[20:23]
buffer_load_dwordx4 v240, s[56:59], s37 offen offset:0 lds
v_mfma_f32_16x16x32_bf16 v[24:27], v[124:127], v[72:75], v[24:27]
v_mfma_f32_16x16x32_bf16 v[28:31], v[96:99], a[16:19], 0
v_mfma_f32_16x16x32_bf16 v[32:35], v[96:99], a[20:23], 0
buffer_load_dwordx4 v241, s[56:59], s37 offen offset:1056 lds
v_mfma_f32_16x16x32_bf16 v[28:31], v[100:103], a[52:55], v[28:31]
v_mfma_f32_16x16x32_bf16 v[32:35], v[100:103], a[56:59], v[32:35]
v_mfma_f32_16x16x32_bf16 v[28:31], v[104:107], a[88:91], v[28:31]
buffer_load_dwordx4 v242, s[56:59], s37 offen offset:2112 lds
v_mfma_f32_16x16x32_bf16 v[32:35], v[104:107], a[92:95], v[32:35]
s_add_u32 s36, s67, 74752
v_mul_f32 v20, v170, v20
v_mfma_f32_16x16x32_bf16 v[28:31], v[108:111], a[124:127], v[28:31]
v_mul_f32 v21, v170, v21
v_mul_f32 v22, v170, v22
v_mfma_f32_16x16x32_bf16 v[32:35], v[108:111], a[128:131], v[32:35]
v_mul_f32 v23, v170, v23
v_mul_f32 v24, v171, v24
v_mfma_f32_16x16x32_bf16 v[28:31], v[112:115], a[160:163], v[28:31]
v_mul_f32 v25, v171, v25
v_mul_f32 v26, v171, v26
v_mfma_f32_16x16x32_bf16 v[32:35], v[112:115], a[164:167], v[32:35]
v_mul_f32 v27, v171, v27
v_cvt_pk_bf16_f32 v20, v20, v21
v_mfma_f32_16x16x32_bf16 v[28:31], v[116:119], a[196:199], v[28:31]
v_cvt_pk_bf16_f32 v21, v22, v23
v_cvt_pk_bf16_f32 v22, v24, v25
v_mfma_f32_16x16x32_bf16 v[32:35], v[116:119], a[200:203], v[32:35]
buffer_load_dwordx4 v243, s[56:59], s37 offen offset:3168 lds
v_cvt_pk_bf16_f32 v23, v26, v27
v_mfma_f32_16x16x32_bf16 v[28:31], v[120:123], a[232:235], v[28:31]
buffer_store_dwordx4 v[20:23], v16, s[60:63], s36 offen sc1
v_mfma_f32_16x16x32_bf16 v[32:35], v[120:123], a[236:239], v[32:35]
v_mfma_f32_16x16x32_bf16 v[28:31], v[124:127], v[76:79], v[28:31]
v_mfma_f32_16x16x32_bf16 v[32:35], v[124:127], v[80:83], v[32:35]
v_mfma_f32_16x16x32_bf16 v[36:39], v[96:99], a[24:27], 0
v_mfma_f32_16x16x32_bf16 v[40:43], v[96:99], a[28:31], 0
v_mfma_f32_16x16x32_bf16 v[36:39], v[100:103], a[60:63], v[36:39]
v_mfma_f32_16x16x32_bf16 v[40:43], v[100:103], a[64:67], v[40:43]
v_mfma_f32_16x16x32_bf16 v[36:39], v[104:107], a[96:99], v[36:39]
v_mfma_f32_16x16x32_bf16 v[40:43], v[104:107], a[100:103], v[40:43]
s_add_u32 s36, s67, 75776
v_mul_f32 v28, v172, v28
v_mfma_f32_16x16x32_bf16 v[36:39], v[108:111], a[132:135], v[36:39]
s_waitcnt vmcnt(14)
s_barrier
v_mfma_f32_16x16x32_bf16 v[40:43], v[108:111], a[136:139], v[40:43]
v_mul_f32 v29, v172, v29
v_mul_f32 v30, v172, v30
v_mfma_f32_16x16x32_bf16 v[36:39], v[112:115], a[168:171], v[36:39]
v_mul_f32 v31, v172, v31
v_mul_f32 v32, v173, v32
v_mfma_f32_16x16x32_bf16 v[40:43], v[112:115], a[172:175], v[40:43]
v_mul_f32 v33, v173, v33
v_mul_f32 v34, v173, v34
v_mfma_f32_16x16x32_bf16 v[36:39], v[116:119], a[204:207], v[36:39]
v_mul_f32 v35, v173, v35
v_cvt_pk_bf16_f32 v28, v28, v29
v_mfma_f32_16x16x32_bf16 v[40:43], v[116:119], a[208:211], v[40:43]
v_cvt_pk_bf16_f32 v29, v30, v31
v_cvt_pk_bf16_f32 v30, v32, v33
v_mfma_f32_16x16x32_bf16 v[36:39], v[120:123], a[240:243], v[36:39]
ds_read_b64_tr_b16 v[128:129], v10 offset:0
v_cvt_pk_bf16_f32 v31, v34, v35
v_mfma_f32_16x16x32_bf16 v[40:43], v[120:123], a[244:247], v[40:43]
buffer_store_dwordx4 v[28:31], v16, s[60:63], s36 offen sc1
v_mfma_f32_16x16x32_bf16 v[36:39], v[124:127], v[84:87], v[36:39]
ds_read_b64_tr_b16 v[130:131], v10 offset:2112
ds_read_b64_tr_b16 v[132:133], v10 offset:4224
ds_read_b64_tr_b16 v[134:135], v10 offset:6336
v_mfma_f32_16x16x32_bf16 v[40:43], v[124:127], v[88:91], v[40:43]
ds_read_b64_tr_b16 v[136:137], v10 offset:8448
ds_read_b64_tr_b16 v[138:139], v10 offset:10560
v_mfma_f32_16x16x32_bf16 v[20:23], v[96:99], a[32:35], 0
ds_read_b64_tr_b16 v[140:141], v10 offset:12672
ds_read_b64_tr_b16 v[142:143], v10 offset:14784
v_mfma_f32_16x16x32_bf16 v[20:23], v[100:103], a[68:71], v[20:23]
ds_read_b64_tr_b16 v[144:145], v10 offset:16896
ds_read_b64_tr_b16 v[146:147], v10 offset:19008
v_mfma_f32_16x16x32_bf16 v[20:23], v[104:107], a[104:107], v[20:23]
ds_read_b64_tr_b16 v[148:149], v10 offset:21120
ds_read_b64_tr_b16 v[150:151], v10 offset:23232
v_mfma_f32_16x16x32_bf16 v[20:23], v[108:111], a[140:143], v[20:23]
ds_read_b64_tr_b16 v[152:153], v10 offset:25344
ds_read_b64_tr_b16 v[154:155], v10 offset:27456
v_mfma_f32_16x16x32_bf16 v[20:23], v[112:115], a[176:179], v[20:23]
ds_read_b64_tr_b16 v[156:157], v10 offset:29568
ds_read_b64_tr_b16 v[158:159], v10 offset:31680
v_mfma_f32_16x16x32_bf16 v[20:23], v[116:119], a[212:215], v[20:23]
v_mfma_f32_16x16x32_bf16 v[20:23], v[120:123], a[248:251], v[20:23]
v_mfma_f32_16x16x32_bf16 v[20:23], v[124:127], v[92:95], v[20:23]
s_waitcnt lgkmcnt(12)
v_mfma_f32_16x16x32_bf16 v[28:31], v[128:131], a[0:3], 0
s_add_u32 s36, s67, 76800
v_mul_f32 v36, v174, v36
v_mfma_f32_16x16x32_bf16 v[32:35], v[128:131], a[4:7], 0
v_mul_f32 v37, v174, v37
v_mul_f32 v38, v174, v38
v_mfma_f32_16x16x32_bf16 v[28:31], v[132:135], a[36:39], v[28:31]
v_mul_f32 v39, v174, v39
v_mul_f32 v40, v175, v40
v_mfma_f32_16x16x32_bf16 v[32:35], v[132:135], a[40:43], v[32:35]
v_mul_f32 v41, v175, v41
s_waitcnt lgkmcnt(8)
v_mfma_f32_16x16x32_bf16 v[28:31], v[136:139], a[72:75], v[28:31]
v_mul_f32 v42, v175, v42
v_mul_f32 v43, v175, v43
v_mfma_f32_16x16x32_bf16 v[32:35], v[136:139], a[76:79], v[32:35]
v_cvt_pk_bf16_f32 v36, v36, v37
v_cvt_pk_bf16_f32 v37, v38, v39
v_mfma_f32_16x16x32_bf16 v[28:31], v[140:143], a[108:111], v[28:31]
v_cvt_pk_bf16_f32 v38, v40, v41
v_cvt_pk_bf16_f32 v39, v42, v43
v_mfma_f32_16x16x32_bf16 v[32:35], v[140:143], a[112:115], v[32:35]
buffer_store_dwordx4 v[36:39], v16, s[60:63], s36 offen sc1
s_waitcnt lgkmcnt(4)
v_mfma_f32_16x16x32_bf16 v[28:31], v[144:147], a[144:147], v[28:31]
s_add_u32 s35, s67, 77824
v_mul_f32 v20, v176, v20
v_mfma_f32_16x16x32_bf16 v[32:35], v[144:147], a[148:151], v[32:35]
v_mul_f32 v21, v176, v21
v_mul_f32 v22, v176, v22
v_mfma_f32_16x16x32_bf16 v[28:31], v[148:151], a[180:183], v[28:31]
v_mul_f32 v23, v176, v23
v_cvt_pk_bf16_f32 v20, v20, v21
v_mfma_f32_16x16x32_bf16 v[32:35], v[148:151], a[184:187], v[32:35]
v_cvt_pk_bf16_f32 v21, v22, v23
s_waitcnt lgkmcnt(0)
v_mfma_f32_16x16x32_bf16 v[28:31], v[152:155], a[216:219], v[28:31]
buffer_store_dwordx2 v[20:21], v17, s[60:63], s35 offen sc1
v_mfma_f32_16x16x32_bf16 v[32:35], v[152:155], a[220:223], v[32:35]
v_mfma_f32_16x16x32_bf16 v[28:31], v[156:159], a[252:255], v[28:31]
v_mfma_f32_16x16x32_bf16 v[32:35], v[156:159], v[64:67], v[32:35]
v_mfma_f32_16x16x32_bf16 v[36:39], v[128:131], a[8:11], 0
v_add_u32 v10, 16896, v6
v_mfma_f32_16x16x32_bf16 v[40:43], v[128:131], a[12:15], 0
v_mfma_f32_16x16x32_bf16 v[36:39], v[132:135], a[44:47], v[36:39]
v_mfma_f32_16x16x32_bf16 v[40:43], v[132:135], a[48:51], v[40:43]
v_mfma_f32_16x16x32_bf16 v[36:39], v[136:139], a[80:83], v[36:39]
v_mfma_f32_16x16x32_bf16 v[40:43], v[136:139], a[84:87], v[40:43]
s_add_u32 s36, s67, 92160
v_mul_f32 v28, v168, v28
v_mfma_f32_16x16x32_bf16 v[36:39], v[140:143], a[116:119], v[36:39]
v_mul_f32 v29, v168, v29
v_mul_f32 v30, v168, v30
v_mfma_f32_16x16x32_bf16 v[40:43], v[140:143], a[120:123], v[40:43]
v_mul_f32 v31, v168, v31
v_mul_f32 v32, v169, v32
v_mfma_f32_16x16x32_bf16 v[36:39], v[144:147], a[152:155], v[36:39]
v_mul_f32 v33, v169, v33
v_mul_f32 v34, v169, v34
v_mfma_f32_16x16x32_bf16 v[40:43], v[144:147], a[156:159], v[40:43]
v_mul_f32 v35, v169, v35
v_cvt_pk_bf16_f32 v28, v28, v29
v_mfma_f32_16x16x32_bf16 v[36:39], v[148:151], a[188:191], v[36:39]
v_cvt_pk_bf16_f32 v29, v30, v31
v_cvt_pk_bf16_f32 v30, v32, v33
v_mfma_f32_16x16x32_bf16 v[40:43], v[148:151], a[192:195], v[40:43]
v_cvt_pk_bf16_f32 v31, v34, v35
v_mfma_f32_16x16x32_bf16 v[36:39], v[152:155], a[224:227], v[36:39]
buffer_store_dwordx4 v[28:31], v16, s[60:63], s36 offen sc1
v_mfma_f32_16x16x32_bf16 v[40:43], v[152:155], a[228:231], v[40:43]
v_mfma_f32_16x16x32_bf16 v[36:39], v[156:159], v[68:71], v[36:39]
v_mfma_f32_16x16x32_bf16 v[40:43], v[156:159], v[72:75], v[40:43]
v_mfma_f32_16x16x32_bf16 v[20:23], v[128:131], a[16:19], 0
v_mfma_f32_16x16x32_bf16 v[24:27], v[128:131], a[20:23], 0
v_mfma_f32_16x16x32_bf16 v[20:23], v[132:135], a[52:55], v[20:23]
v_mfma_f32_16x16x32_bf16 v[24:27], v[132:135], a[56:59], v[24:27]
v_mfma_f32_16x16x32_bf16 v[20:23], v[136:139], a[88:91], v[20:23]
v_mfma_f32_16x16x32_bf16 v[24:27], v[136:139], a[92:95], v[24:27]
s_add_u32 s36, s67, 93184
v_mul_f32 v36, v170, v36
v_mfma_f32_16x16x32_bf16 v[20:23], v[140:143], a[124:127], v[20:23]
v_mul_f32 v37, v170, v37
v_mul_f32 v38, v170, v38
v_mfma_f32_16x16x32_bf16 v[24:27], v[140:143], a[128:131], v[24:27]
v_mul_f32 v39, v170, v39
v_mul_f32 v40, v171, v40
v_mfma_f32_16x16x32_bf16 v[20:23], v[144:147], a[160:163], v[20:23]
v_mul_f32 v41, v171, v41
v_mul_f32 v42, v171, v42
v_mfma_f32_16x16x32_bf16 v[24:27], v[144:147], a[164:167], v[24:27]
v_mul_f32 v43, v171, v43
v_cvt_pk_bf16_f32 v36, v36, v37
v_mfma_f32_16x16x32_bf16 v[20:23], v[148:151], a[196:199], v[20:23]
v_cvt_pk_bf16_f32 v37, v38, v39
v_cvt_pk_bf16_f32 v38, v40, v41
v_mfma_f32_16x16x32_bf16 v[24:27], v[148:151], a[200:203], v[24:27]
v_cvt_pk_bf16_f32 v39, v42, v43
v_mfma_f32_16x16x32_bf16 v[20:23], v[152:155], a[232:235], v[20:23]
buffer_store_dwordx4 v[36:39], v16, s[60:63], s36 offen sc1
v_mfma_f32_16x16x32_bf16 v[24:27], v[152:155], a[236:239], v[24:27]
v_mfma_f32_16x16x32_bf16 v[20:23], v[156:159], v[76:79], v[20:23]
v_mfma_f32_16x16x32_bf16 v[24:27], v[156:159], v[80:83], v[24:27]
v_mfma_f32_16x16x32_bf16 v[28:31], v[128:131], a[24:27], 0
v_mfma_f32_16x16x32_bf16 v[32:35], v[128:131], a[28:31], 0
v_mfma_f32_16x16x32_bf16 v[28:31], v[132:135], a[60:63], v[28:31]
v_mfma_f32_16x16x32_bf16 v[32:35], v[132:135], a[64:67], v[32:35]
v_mfma_f32_16x16x32_bf16 v[28:31], v[136:139], a[96:99], v[28:31]
v_mfma_f32_16x16x32_bf16 v[32:35], v[136:139], a[100:103], v[32:35]
s_add_u32 s36, s67, 94208
v_mul_f32 v20, v172, v20
v_mfma_f32_16x16x32_bf16 v[28:31], v[140:143], a[132:135], v[28:31]
s_waitcnt vmcnt(6)
s_barrier
v_mfma_f32_16x16x32_bf16 v[32:35], v[140:143], a[136:139], v[32:35]
v_mul_f32 v21, v172, v21
v_mul_f32 v22, v172, v22
v_mfma_f32_16x16x32_bf16 v[28:31], v[144:147], a[168:171], v[28:31]
v_mul_f32 v23, v172, v23
v_mul_f32 v24, v173, v24
v_mfma_f32_16x16x32_bf16 v[32:35], v[144:147], a[172:175], v[32:35]
v_mul_f32 v25, v173, v25
v_mul_f32 v26, v173, v26
v_mfma_f32_16x16x32_bf16 v[28:31], v[148:151], a[204:207], v[28:31]
v_mul_f32 v27, v173, v27
v_cvt_pk_bf16_f32 v20, v20, v21
v_mfma_f32_16x16x32_bf16 v[32:35], v[148:151], a[208:211], v[32:35]
v_cvt_pk_bf16_f32 v21, v22, v23
v_cvt_pk_bf16_f32 v22, v24, v25
v_mfma_f32_16x16x32_bf16 v[28:31], v[152:155], a[240:243], v[28:31]
ds_read_b64_tr_b16 v[96:97], v10 offset:0
v_cvt_pk_bf16_f32 v23, v26, v27
v_mfma_f32_16x16x32_bf16 v[32:35], v[152:155], a[244:247], v[32:35]
buffer_store_dwordx4 v[20:23], v16, s[60:63], s36 offen sc1
v_mfma_f32_16x16x32_bf16 v[28:31], v[156:159], v[84:87], v[28:31]
ds_read_b64_tr_b16 v[98:99], v10 offset:2112
ds_read_b64_tr_b16 v[100:101], v10 offset:4224
ds_read_b64_tr_b16 v[102:103], v10 offset:6336
v_mfma_f32_16x16x32_bf16 v[32:35], v[156:159], v[88:91], v[32:35]
ds_read_b64_tr_b16 v[104:105], v10 offset:8448
ds_read_b64_tr_b16 v[106:107], v10 offset:10560
v_mfma_f32_16x16x32_bf16 v[36:39], v[128:131], a[32:35], 0
ds_read_b64_tr_b16 v[108:109], v10 offset:12672
ds_read_b64_tr_b16 v[110:111], v10 offset:14784
v_mfma_f32_16x16x32_bf16 v[36:39], v[132:135], a[68:71], v[36:39]
ds_read_b64_tr_b16 v[112:113], v10 offset:16896
ds_read_b64_tr_b16 v[114:115], v10 offset:19008
v_mfma_f32_16x16x32_bf16 v[36:39], v[136:139], a[104:107], v[36:39]
ds_read_b64_tr_b16 v[116:117], v10 offset:21120
ds_read_b64_tr_b16 v[118:119], v10 offset:23232
v_mfma_f32_16x16x32_bf16 v[36:39], v[140:143], a[140:143], v[36:39]
ds_read_b64_tr_b16 v[120:121], v10 offset:25344
ds_read_b64_tr_b16 v[122:123], v10 offset:27456
v_mfma_f32_16x16x32_bf16 v[36:39], v[144:147], a[176:179], v[36:39]
ds_read_b64_tr_b16 v[124:125], v10 offset:29568
ds_read_b64_tr_b16 v[126:127], v10 offset:31680
v_mfma_f32_16x16x32_bf16 v[36:39], v[148:151], a[212:215], v[36:39]
v_mfma_f32_16x16x32_bf16 v[36:39], v[152:155], a[248:251], v[36:39]
v_mfma_f32_16x16x32_bf16 v[36:39], v[156:159], v[92:95], v[36:39]
s_waitcnt lgkmcnt(12)
v_mfma_f32_16x16x32_bf16 v[20:23], v[96:99], a[0:3], 0
s_add_u32 s36, s67, 95232
v_mul_f32 v28, v174, v28
v_mfma_f32_16x16x32_bf16 v[24:27], v[96:99], a[4:7], 0
v_mul_f32 v29, v174, v29
v_mul_f32 v30, v174, v30
v_mfma_f32_16x16x32_bf16 v[20:23], v[100:103], a[36:39], v[20:23]
v_mul_f32 v31, v174, v31
v_mul_f32 v32, v175, v32
v_mfma_f32_16x16x32_bf16 v[24:27], v[100:103], a[40:43], v[24:27]
v_mul_f32 v33, v175, v33
s_waitcnt lgkmcnt(8)
v_mfma_f32_16x16x32_bf16 v[20:23], v[104:107], a[72:75], v[20:23]
v_mul_f32 v34, v175, v34
v_mul_f32 v35, v175, v35
v_mfma_f32_16x16x32_bf16 v[24:27], v[104:107], a[76:79], v[24:27]
v_cvt_pk_bf16_f32 v28, v28, v29
v_cvt_pk_bf16_f32 v29, v30, v31
v_mfma_f32_16x16x32_bf16 v[20:23], v[108:111], a[108:111], v[20:23]
v_cvt_pk_bf16_f32 v30, v32, v33
v_cvt_pk_bf16_f32 v31, v34, v35
v_mfma_f32_16x16x32_bf16 v[24:27], v[108:111], a[112:115], v[24:27]
buffer_store_dwordx4 v[28:31], v16, s[60:63], s36 offen sc1
s_waitcnt lgkmcnt(4)
v_mfma_f32_16x16x32_bf16 v[20:23], v[112:115], a[144:147], v[20:23]
s_add_u32 s35, s67, 96256
v_mul_f32 v36, v176, v36
v_mfma_f32_16x16x32_bf16 v[24:27], v[112:115], a[148:151], v[24:27]
v_mul_f32 v37, v176, v37
v_mul_f32 v38, v176, v38
v_mfma_f32_16x16x32_bf16 v[20:23], v[116:119], a[180:183], v[20:23]
v_mul_f32 v39, v176, v39
v_cvt_pk_bf16_f32 v36, v36, v37
v_mfma_f32_16x16x32_bf16 v[24:27], v[116:119], a[184:187], v[24:27]
v_cvt_pk_bf16_f32 v37, v38, v39
s_waitcnt lgkmcnt(0)
v_mfma_f32_16x16x32_bf16 v[20:23], v[120:123], a[216:219], v[20:23]
buffer_store_dwordx2 v[36:37], v17, s[60:63], s35 offen sc1
v_mfma_f32_16x16x32_bf16 v[24:27], v[120:123], a[220:223], v[24:27]
v_mfma_f32_16x16x32_bf16 v[20:23], v[124:127], a[252:255], v[20:23]
v_mfma_f32_16x16x32_bf16 v[24:27], v[124:127], v[64:67], v[24:27]
v_mfma_f32_16x16x32_bf16 v[28:31], v[96:99], a[8:11], 0
v_mfma_f32_16x16x32_bf16 v[32:35], v[96:99], a[12:15], 0
v_mfma_f32_16x16x32_bf16 v[28:31], v[100:103], a[44:47], v[28:31]
v_mfma_f32_16x16x32_bf16 v[32:35], v[100:103], a[48:51], v[32:35]
v_mfma_f32_16x16x32_bf16 v[28:31], v[104:107], a[80:83], v[28:31]
v_mfma_f32_16x16x32_bf16 v[32:35], v[104:107], a[84:87], v[32:35]
s_add_u32 s36, s67, 110592
v_mul_f32 v20, v168, v20
v_mfma_f32_16x16x32_bf16 v[28:31], v[108:111], a[116:119], v[28:31]
v_mul_f32 v21, v168, v21
v_mul_f32 v22, v168, v22
v_mfma_f32_16x16x32_bf16 v[32:35], v[108:111], a[120:123], v[32:35]
v_mul_f32 v23, v168, v23
v_mul_f32 v24, v169, v24
v_mfma_f32_16x16x32_bf16 v[28:31], v[112:115], a[152:155], v[28:31]
v_mul_f32 v25, v169, v25
v_mul_f32 v26, v169, v26
v_mfma_f32_16x16x32_bf16 v[32:35], v[112:115], a[156:159], v[32:35]
v_mul_f32 v27, v169, v27
v_cvt_pk_bf16_f32 v20, v20, v21
v_mfma_f32_16x16x32_bf16 v[28:31], v[116:119], a[188:191], v[28:31]
v_cvt_pk_bf16_f32 v21, v22, v23
v_cvt_pk_bf16_f32 v22, v24, v25
v_mfma_f32_16x16x32_bf16 v[32:35], v[116:119], a[192:195], v[32:35]
v_cvt_pk_bf16_f32 v23, v26, v27
v_mfma_f32_16x16x32_bf16 v[28:31], v[120:123], a[224:227], v[28:31]
buffer_store_dwordx4 v[20:23], v16, s[60:63], s36 offen sc1
v_mfma_f32_16x16x32_bf16 v[32:35], v[120:123], a[228:231], v[32:35]
v_mfma_f32_16x16x32_bf16 v[28:31], v[124:127], v[68:71], v[28:31]
v_mfma_f32_16x16x32_bf16 v[32:35], v[124:127], v[72:75], v[32:35]
v_mfma_f32_16x16x32_bf16 v[36:39], v[96:99], a[16:19], 0
v_mfma_f32_16x16x32_bf16 v[40:43], v[96:99], a[20:23], 0
v_mfma_f32_16x16x32_bf16 v[36:39], v[100:103], a[52:55], v[36:39]
v_mfma_f32_16x16x32_bf16 v[40:43], v[100:103], a[56:59], v[40:43]
v_mfma_f32_16x16x32_bf16 v[36:39], v[104:107], a[88:91], v[36:39]
v_mfma_f32_16x16x32_bf16 v[40:43], v[104:107], a[92:95], v[40:43]
s_add_u32 s36, s67, 111616
v_mul_f32 v28, v170, v28
v_mfma_f32_16x16x32_bf16 v[36:39], v[108:111], a[124:127], v[36:39]
v_mul_f32 v29, v170, v29
v_mul_f32 v30, v170, v30
v_mfma_f32_16x16x32_bf16 v[40:43], v[108:111], a[128:131], v[40:43]
v_mul_f32 v31, v170, v31
v_mul_f32 v32, v171, v32
v_mfma_f32_16x16x32_bf16 v[36:39], v[112:115], a[160:163], v[36:39]
v_mul_f32 v33, v171, v33
v_mul_f32 v34, v171, v34
v_mfma_f32_16x16x32_bf16 v[40:43], v[112:115], a[164:167], v[40:43]
v_mul_f32 v35, v171, v35
v_cvt_pk_bf16_f32 v28, v28, v29
v_mfma_f32_16x16x32_bf16 v[36:39], v[116:119], a[196:199], v[36:39]
v_cvt_pk_bf16_f32 v29, v30, v31
v_cvt_pk_bf16_f32 v30, v32, v33
v_mfma_f32_16x16x32_bf16 v[40:43], v[116:119], a[200:203], v[40:43]
v_cvt_pk_bf16_f32 v31, v34, v35
v_mfma_f32_16x16x32_bf16 v[36:39], v[120:123], a[232:235], v[36:39]
buffer_store_dwordx4 v[28:31], v16, s[60:63], s36 offen sc1
v_mfma_f32_16x16x32_bf16 v[40:43], v[120:123], a[236:239], v[40:43]
v_mfma_f32_16x16x32_bf16 v[36:39], v[124:127], v[76:79], v[36:39]
v_mfma_f32_16x16x32_bf16 v[40:43], v[124:127], v[80:83], v[40:43]
v_mfma_f32_16x16x32_bf16 v[20:23], v[96:99], a[24:27], 0
v_mfma_f32_16x16x32_bf16 v[24:27], v[96:99], a[28:31], 0
v_mfma_f32_16x16x32_bf16 v[20:23], v[100:103], a[60:63], v[20:23]
v_mfma_f32_16x16x32_bf16 v[24:27], v[100:103], a[64:67], v[24:27]
v_mfma_f32_16x16x32_bf16 v[20:23], v[104:107], a[96:99], v[20:23]
v_mfma_f32_16x16x32_bf16 v[24:27], v[104:107], a[100:103], v[24:27]
s_add_u32 s36, s67, 112640
v_mul_f32 v36, v172, v36
v_mfma_f32_16x16x32_bf16 v[20:23], v[108:111], a[132:135], v[20:23]
v_mul_f32 v37, v172, v37
v_mul_f32 v38, v172, v38
v_mfma_f32_16x16x32_bf16 v[24:27], v[108:111], a[136:139], v[24:27]
v_mul_f32 v39, v172, v39
v_mul_f32 v40, v173, v40
v_mfma_f32_16x16x32_bf16 v[20:23], v[112:115], a[168:171], v[20:23]
v_mul_f32 v41, v173, v41
v_mul_f32 v42, v173, v42
v_mfma_f32_16x16x32_bf16 v[24:27], v[112:115], a[172:175], v[24:27]
v_mul_f32 v43, v173, v43
v_cvt_pk_bf16_f32 v36, v36, v37
v_mfma_f32_16x16x32_bf16 v[20:23], v[116:119], a[204:207], v[20:23]
v_cvt_pk_bf16_f32 v37, v38, v39
v_cvt_pk_bf16_f32 v38, v40, v41
v_mfma_f32_16x16x32_bf16 v[24:27], v[116:119], a[208:211], v[24:27]
v_cvt_pk_bf16_f32 v39, v42, v43
v_mfma_f32_16x16x32_bf16 v[20:23], v[120:123], a[240:243], v[20:23]
buffer_store_dwordx4 v[36:39], v16, s[60:63], s36 offen sc1
v_mfma_f32_16x16x32_bf16 v[24:27], v[120:123], a[244:247], v[24:27]
v_mfma_f32_16x16x32_bf16 v[20:23], v[124:127], v[84:87], v[20:23]
v_mfma_f32_16x16x32_bf16 v[24:27], v[124:127], v[88:91], v[24:27]
v_mfma_f32_16x16x32_bf16 v[28:31], v[96:99], a[32:35], 0
v_mfma_f32_16x16x32_bf16 v[28:31], v[100:103], a[68:71], v[28:31]
v_mfma_f32_16x16x32_bf16 v[28:31], v[104:107], a[104:107], v[28:31]
v_mfma_f32_16x16x32_bf16 v[28:31], v[108:111], a[140:143], v[28:31]
v_mfma_f32_16x16x32_bf16 v[28:31], v[112:115], a[176:179], v[28:31]
v_mfma_f32_16x16x32_bf16 v[28:31], v[116:119], a[212:215], v[28:31]
v_mfma_f32_16x16x32_bf16 v[28:31], v[120:123], a[248:251], v[28:31]
v_mfma_f32_16x16x32_bf16 v[28:31], v[124:127], v[92:95], v[28:31]
s_add_u32 s36, s67, 113664
v_mul_f32 v20, v174, v20
v_mul_f32 v21, v174, v21
v_mul_f32 v22, v174, v22
v_mul_f32 v23, v174, v23
v_mul_f32 v24, v175, v24
v_mul_f32 v25, v175, v25
v_mul_f32 v26, v175, v26
v_mul_f32 v27, v175, v27
v_cvt_pk_bf16_f32 v20, v20, v21
v_cvt_pk_bf16_f32 v21, v22, v23
v_cvt_pk_bf16_f32 v22, v24, v25
v_cvt_pk_bf16_f32 v23, v26, v27
buffer_store_dwordx4 v[20:23], v16, s[60:63], s36 offen sc1
s_add_u32 s35, s67, 114688
v_mul_f32 v28, v176, v28
v_mul_f32 v29, v176, v29
v_mul_f32 v30, v176, v30
v_mul_f32 v31, v176, v31
v_cvt_pk_bf16_f32 v28, v28, v29
v_cvt_pk_bf16_f32 v29, v30, v31
buffer_store_dwordx2 v[28:29], v17, s[60:63], s35 offen sc1
v_lshrrev_b32 v20, 4, v58
v_mul_u32_u24 v21, 3641, v20
v_lshrrev_b32 v21, 22, v21
v_mul_u32_u24 v22, 1152, v21
v_sub_u32 v22, v20, v22
v_mul_u32_u24 v23, 911, v22
v_lshrrev_b32 v23, 18, v23
v_mul_u32_u24 v24, 288, v23
v_sub_u32 v24, v22, v24
s_mul_i32 s35, s33, 258048
s_mul_i32 s36, s32, 896
s_add_u32 s35, s35, s36
v_lshlrev_b32 v21, 7, v21
v_lshl_add_u32 v21, v23, 5, v21
v_add_u32 v21, s35, v21
v_lshrrev_b32 v25, 6, v24
v_and_b32 v26, 15, v24
v_lshl_add_u32 v25, v25, 5, v26
v_bfe_u32 v26, v24, 4, 2
v_lshlrev_b32 v27, 1, v24
v_and_b32 v27, 15, v27
v_add_u32 v27, 128, v27
v_bfe_u32 v28, v24, 3, 2
v_cmp_gt_u32 vcc, 256, v24
v_mov_b32 v29, 1792
v_mov_b32 v30, 28672
v_cndmask_b32 v25, v27, v25, vcc
v_cndmask_b32 v26, v28, v26, vcc
v_cndmask_b32 v29, v29, v30, vcc
v_mul_u32_u24 v25, 1792, v25
v_add_u32 v25, v25, v21
v_lshl_add_u32 v32, v26, 3, v25
v_cmp_lt_u32 vcc, v58, v52
s_nop 1
v_cndmask_b32 v32, v52, v32, vcc
v_add_u32 v33, v32, v29
v_lshrrev_b32 v20, 4, v59
v_mul_u32_u24 v21, 3641, v20
v_lshrrev_b32 v21, 22, v21
v_mul_u32_u24 v22, 1152, v21
v_sub_u32 v22, v20, v22
v_mul_u32_u24 v23, 911, v22
v_lshrrev_b32 v23, 18, v23
v_mul_u32_u24 v24, 288, v23
v_sub_u32 v24, v22, v24
s_mul_i32 s35, s33, 258048
s_mul_i32 s36, s32, 896
s_add_u32 s35, s35, s36
v_lshlrev_b32 v21, 7, v21
v_lshl_add_u32 v21, v23, 5, v21
v_add_u32 v21, s35, v21
v_lshrrev_b32 v25, 6, v24
v_and_b32 v26, 15, v24
v_lshl_add_u32 v25, v25, 5, v26
v_bfe_u32 v26, v24, 4, 2
v_lshlrev_b32 v27, 1, v24
v_and_b32 v27, 15, v27
v_add_u32 v27, 128, v27
v_bfe_u32 v28, v24, 3, 2
v_cmp_gt_u32 vcc, 256, v24
v_mov_b32 v29, 1792
v_mov_b32 v30, 28672
v_cndmask_b32 v25, v27, v25, vcc
v_cndmask_b32 v26, v28, v26, vcc
v_cndmask_b32 v29, v29, v30, vcc
v_mul_u32_u24 v25, 1792, v25
v_add_u32 v25, v25, v21
v_lshl_add_u32 v34, v26, 3, v25
v_cmp_lt_u32 vcc, v59, v52
s_nop 1
v_cndmask_b32 v34, v52, v34, vcc
v_add_u32 v35, v34, v29
v_mov_b32 v36, 0x3f80
v_mov_b32 v37, 0x3f800000
s_waitcnt vmcnt(0)
s_mov_b32 s17, 0x40000
L_tag:
v_cmp_eq_u32 vcc, 0, v63
s_cbranch_vccz L_tagok
s_sub_u32 s17, s17, 1
s_cbranch_scc1 L_tagok
s_sleep 2
global_load_dword v63, v57, s[18:19] sc1
s_waitcnt vmcnt(0)
s_branch L_tag
L_tagok:
v_mov_b32 v44, v63
v_mov_b32 v45, v63
v_mov_b32 v46, v63
v_mov_b32 v47, v63
s_barrier
buffer_store_dwordx4 v[44:47], v62, s[8:11], s70 offen sc1
s_add_u32 s70, s70, 16384
buffer_store_dwordx4 v[44:47], v62, s[8:11], s70 offen sc1
buffer_load_dword v56, v60, s[8:11], 0 offen sc1
s_waitcnt vmcnt(0)
s_mov_b32 s17, 0x40000
L_p1:
v_cmp_ne_u32 vcc, v63, v56
s_cbranch_vccz L_p1ok
s_sub_u32 s17, s17, 1
s_cbranch_scc1 L_p1ok
s_sleep 2
buffer_load_dword v56, v60, s[8:11], 0 offen sc1
s_waitcnt vmcnt(0)
s_branch L_p1
L_p1ok:
s_mov_b32 s35, 0
buffer_load_dwordx4 v[180:183], v58, s[4:7], s35 offen sc1
s_mov_b32 s35, 129024
buffer_load_dwordx4 v[184:187], v58, s[4:7], s35 offen sc1
s_mov_b32 s35, 258048
buffer_load_dwordx4 v[188:191], v58, s[4:7], s35 offen sc1
s_mov_b32 s35, 387072
buffer_load_dwordx4 v[192:195], v58, s[4:7], s35 offen sc1
s_mov_b32 s35, 516096
buffer_load_dwordx4 v[196:199], v58, s[4:7], s35 offen sc1
s_mov_b32 s35, 645120
buffer_load_dwordx4 v[200:203], v58, s[4:7], s35 offen sc1
s_mov_b32 s35, 774144
buffer_load_dwordx4 v[204:207], v58, s[4:7], s35 offen sc1
s_mov_b32 s35, 903168
buffer_load_dwordx4 v[208:211], v58, s[4:7], s35 offen sc1
s_mov_b32 s35, 1032192
buffer_load_dwordx4 v[212:215], v58, s[4:7], s35 offen sc1
s_mov_b32 s35, 1161216
buffer_load_dwordx4 v[216:219], v58, s[4:7], s35 offen sc1
s_mov_b32 s35, 1290240
buffer_load_dwordx4 v[220:223], v58, s[4:7], s35 offen sc1
s_mov_b32 s35, 1419264
buffer_load_dwordx4 v[224:227], v58, s[4:7], s35 offen sc1
s_mov_b32 s35, 1548288
buffer_load_dwordx4 v[228:231], v58, s[4:7], s35 offen sc1
s_mov_b32 s35, 1677312
buffer_load_dwordx4 v[232:235], v58, s[4:7], s35 offen sc1
s_mov_b32 s35, 1806336
buffer_load_dwordx4 v[236:239], v58, s[4:7], s35 offen sc1
s_mov_b32 s35, 1935360
buffer_load_dwordx4 v[240:243], v58, s[4:7], s35 offen sc1
s_mov_b32 s35, 0
buffer_load_dwordx4 v[96:99], v59, s[4:7], s35 offen sc1
s_mov_b32 s35, 129024
buffer_load_dwordx4 v[100:103], v59, s[4:7], s35 offen sc1
s_mov_b32 s35, 258048
buffer_load_dwordx4 v[104:107], v59, s[4:7], s35 offen sc1
s_mov_b32 s35, 387072
buffer_load_dwordx4 v[108:111], v59, s[4:7], s35 offen sc1
s_mov_b32 s35, 516096
buffer_load_dwordx4 v[112:115], v59, s[4:7], s35 offen sc1
s_mov_b32 s35, 645120
buffer_load_dwordx4 v[116:119], v59, s[4:7], s35 offen sc1
s_mov_b32 s35, 774144
buffer_load_dwordx4 v[120:123], v59, s[4:7], s35 offen sc1
s_mov_b32 s35, 903168
buffer_load_dwordx4 v[124:127], v59, s[4:7], s35 offen sc1
s_mov_b32 s35, 1032192
buffer_load_dwordx4 v[128:131], v59, s[4:7], s35 offen sc1
s_mov_b32 s35, 1161216
buffer_load_dwordx4 v[132:135], v59, s[4:7], s35 offen sc1
s_mov_b32 s35, 1290240
buffer_load_dwordx4 v[136:139], v59, s[4:7], s35 offen sc1
s_mov_b32 s35, 1419264
buffer_load_dwordx4 v[140:143], v59, s[4:7], s35 offen sc1
s_mov_b32 s35, 1548288
buffer_load_dwordx4 v[144:147], v59, s[4:7], s35 offen sc1
s_mov_b32 s35, 1677312
buffer_load_dwordx4 v[148:151], v59, s[4:7], s35 offen sc1
s_mov_b32 s35, 1806336
buffer_load_dwordx4 v[152:155], v59, s[4:7], s35 offen sc1
s_mov_b32 s35, 1935360
buffer_load_dwordx4 v[156:159], v59, s[4:7], s35 offen sc1
s_waitcnt vmcnt(31)
v_dot2_f32_bf16 v40, v180, v36, 0
v_dot2_f32_bf16 v41, v180, v37, 0
v_dot2_f32_bf16 v42, v181, v36, 0
v_dot2_f32_bf16 v43, v181, v37, 0
v_dot2_f32_bf16 v44, v182, v36, 0
v_dot2_f32_bf16 v45, v182, v37, 0
v_dot2_f32_bf16 v46, v183, v36, 0
v_dot2_f32_bf16 v47, v183, v37, 0
s_waitcnt vmcnt(30)
v_dot2_f32_bf16 v40, v184, v36, v40
v_dot2_f32_bf16 v41, v184, v37, v41
v_dot2_f32_bf16 v42, v185, v36, v42
v_dot2_f32_bf16 v43, v185, v37, v43
v_dot2_f32_bf16 v44, v186, v36, v44
v_dot2_f32_bf16 v45, v186, v37, v45
v_dot2_f32_bf16 v46, v187, v36, v46
v_dot2_f32_bf16 v47, v187, v37, v47
s_waitcnt vmcnt(29)
v_dot2_f32_bf16 v40, v188, v36, v40
v_dot2_f32_bf16 v41, v188, v37, v41
v_dot2_f32_bf16 v42, v189, v36, v42
v_dot2_f32_bf16 v43, v189, v37, v43
v_dot2_f32_bf16 v44, v190, v36, v44
v_dot2_f32_bf16 v45, v190, v37, v45
v_dot2_f32_bf16 v46, v191, v36, v46
v_dot2_f32_bf16 v47, v191, v37, v47
s_waitcnt vmcnt(28)
v_dot2_f32_bf16 v40, v192, v36, v40
v_dot2_f32_bf16 v41, v192, v37, v41
v_dot2_f32_bf16 v42, v193, v36, v42
v_dot2_f32_bf16 v43, v193, v37, v43
v_dot2_f32_bf16 v44, v194, v36, v44
v_dot2_f32_bf16 v45, v194, v37, v45
v_dot2_f32_bf16 v46, v195, v36, v46
v_dot2_f32_bf16 v47, v195, v37, v47
s_waitcnt vmcnt(27)
v_dot2_f32_bf16 v40, v196, v36, v40
v_dot2_f32_bf16 v41, v196, v37, v41
v_dot2_f32_bf16 v42, v197, v36, v42
v_dot2_f32_bf16 v43, v197, v37, v43
v_dot2_f32_bf16 v44, v198, v36, v44
v_dot2_f32_bf16 v45, v198, v37, v45
v_dot2_f32_bf16 v46, v199, v36, v46
v_dot2_f32_bf16 v47, v199, v37, v47
s_waitcnt vmcnt(26)
v_dot2_f32_bf16 v40, v200, v36, v40
v_dot2_f32_bf16 v41, v200, v37, v41
v_dot2_f32_bf16 v42, v201, v36, v42
v_dot2_f32_bf16 v43, v201, v37, v43
v_dot2_f32_bf16 v44, v202, v36, v44
v_dot2_f32_bf16 v45, v202, v37, v45
v_dot2_f32_bf16 v46, v203, v36, v46
v_dot2_f32_bf16 v47, v203, v37, v47
s_waitcnt vmcnt(25)
v_dot2_f32_bf16 v40, v204, v36, v40
v_dot2_f32_bf16 v41, v204, v37, v41
v_dot2_f32_bf16 v42, v205, v36, v42
v_dot2_f32_bf16 v43, v205, v37, v43
v_dot2_f32_bf16 v44, v206, v36, v44
v_dot2_f32_bf16 v45, v206, v37, v45
v_dot2_f32_bf16 v46, v207, v36, v46
v_dot2_f32_bf16 v47, v207, v37, v47
s_waitcnt vmcnt(24)
v_dot2_f32_bf16 v40, v208, v36, v40
v_dot2_f32_bf16 v41, v208, v37, v41
v_dot2_f32_bf16 v42, v209, v36, v42
v_dot2_f32_bf16 v43, v209, v37, v43
v_dot2_f32_bf16 v44, v210, v36, v44
v_dot2_f32_bf16 v45, v210, v37, v45
v_dot2_f32_bf16 v46, v211, v36, v46
v_dot2_f32_bf16 v47, v211, v37, v47
s_waitcnt vmcnt(23)
v_dot2_f32_bf16 v40, v212, v36, v40
v_dot2_f32_bf16 v41, v212, v37, v41
v_dot2_f32_bf16 v42, v213, v36, v42
v_dot2_f32_bf16 v43, v213, v37, v43
v_dot2_f32_bf16 v44, v214, v36, v44
v_dot2_f32_bf16 v45, v214, v37, v45
v_dot2_f32_bf16 v46, v215, v36, v46
v_dot2_f32_bf16 v47, v215, v37, v47
s_waitcnt vmcnt(22)
v_dot2_f32_bf16 v40, v216, v36, v40
v_dot2_f32_bf16 v41, v216, v37, v41
v_dot2_f32_bf16 v42, v217, v36, v42
v_dot2_f32_bf16 v43, v217, v37, v43
v_dot2_f32_bf16 v44, v218, v36, v44
v_dot2_f32_bf16 v45, v218, v37, v45
v_dot2_f32_bf16 v46, v219, v36, v46
v_dot2_f32_bf16 v47, v219, v37, v47
s_waitcnt vmcnt(21)
v_dot2_f32_bf16 v40, v220, v36, v40
v_dot2_f32_bf16 v41, v220, v37, v41
v_dot2_f32_bf16 v42, v221, v36, v42
v_dot2_f32_bf16 v43, v221, v37, v43
v_dot2_f32_bf16 v44, v222, v36, v44
v_dot2_f32_bf16 v45, v222, v37, v45
v_dot2_f32_bf16 v46, v223, v36, v46
v_dot2_f32_bf16 v47, v223, v37, v47
s_waitcnt vmcnt(20)
v_dot2_f32_bf16 v40, v224, v36, v40
v_dot2_f32_bf16 v41, v224, v37, v41
v_dot2_f32_bf16 v42, v225, v36, v42
v_dot2_f32_bf16 v43, v225, v37, v43
v_dot2_f32_bf16 v44, v226, v36, v44
v_dot2_f32_bf16 v45, v226, v37, v45
v_dot2_f32_bf16 v46, v227, v36, v46
v_dot2_f32_bf16 v47, v227, v37, v47
s_waitcnt vmcnt(19)
v_dot2_f32_bf16 v40, v228, v36, v40
v_dot2_f32_bf16 v41, v228, v37, v41
v_dot2_f32_bf16 v42, v229, v36, v42
v_dot2_f32_bf16 v43, v229, v37, v43
v_dot2_f32_bf16 v44, v230, v36, v44
v_dot2_f32_bf16 v45, v230, v37, v45
v_dot2_f32_bf16 v46, v231, v36, v46
v_dot2_f32_bf16 v47, v231, v37, v47
s_waitcnt vmcnt(18)
v_dot2_f32_bf16 v40, v232, v36, v40
v_dot2_f32_bf16 v41, v232, v37, v41
v_dot2_f32_bf16 v42, v233, v36, v42
v_dot2_f32_bf16 v43, v233, v37, v43
v_dot2_f32_bf16 v44, v234, v36, v44
v_dot2_f32_bf16 v45, v234, v37, v45
v_dot2_f32_bf16 v46, v235, v36, v46
v_dot2_f32_bf16 v47, v235, v37, v47
s_waitcnt vmcnt(17)
v_dot2_f32_bf16 v40, v236, v36, v40
v_dot2_f32_bf16 v41, v236, v37, v41
v_dot2_f32_bf16 v42, v237, v36, v42
v_dot2_f32_bf16 v43, v237, v37, v43
v_dot2_f32_bf16 v44, v238, v36, v44
v_dot2_f32_bf16 v45, v238, v37, v45
v_dot2_f32_bf16 v46, v239, v36, v46
v_dot2_f32_bf16 v47, v239, v37, v47
s_waitcnt vmcnt(16)
v_dot2_f32_bf16 v40, v240, v36, v40
v_dot2_f32_bf16 v41, v240, v37, v41
v_dot2_f32_bf16 v42, v241, v36, v42
v_dot2_f32_bf16 v43, v241, v37, v43
v_dot2_f32_bf16 v44, v242, v36, v44
v_dot2_f32_bf16 v45, v242, v37, v45
v_dot2_f32_bf16 v46, v243, v36, v46
v_dot2_f32_bf16 v47, v243, v37, v47
s_nop 2
v_cvt_pk_bf16_f32 v48, v40, v41
v_cvt_pk_bf16_f32 v49, v42, v43
v_cvt_pk_bf16_f32 v50, v44, v45
v_cvt_pk_bf16_f32 v51, v46, v47
buffer_store_dwordx2 v[48:49], v32, s[12:15], 0 offen
buffer_store_dwordx2 v[50:51], v33, s[12:15], 0 offen
s_waitcnt vmcnt(15)
v_dot2_f32_bf16 v40, v96, v36, 0
v_dot2_f32_bf16 v41, v96, v37, 0
v_dot2_f32_bf16 v42, v97, v36, 0
v_dot2_f32_bf16 v43, v97, v37, 0
v_dot2_f32_bf16 v44, v98, v36, 0
v_dot2_f32_bf16 v45, v98, v37, 0
v_dot2_f32_bf16 v46, v99, v36, 0
v_dot2_f32_bf16 v47, v99, v37, 0
s_waitcnt vmcnt(14)
v_dot2_f32_bf16 v40, v100, v36, v40
v_dot2_f32_bf16 v41, v100, v37, v41
v_dot2_f32_bf16 v42, v101, v36, v42
v_dot2_f32_bf16 v43, v101, v37, v43
v_dot2_f32_bf16 v44, v102, v36, v44
v_dot2_f32_bf16 v45, v102, v37, v45
v_dot2_f32_bf16 v46, v103, v36, v46
v_dot2_f32_bf16 v47, v103, v37, v47
s_waitcnt vmcnt(13)
v_dot2_f32_bf16 v40, v104, v36, v40
v_dot2_f32_bf16 v41, v104, v37, v41
v_dot2_f32_bf16 v42, v105, v36, v42
v_dot2_f32_bf16 v43, v105, v37, v43
v_dot2_f32_bf16 v44, v106, v36, v44
v_dot2_f32_bf16 v45, v106, v37, v45
v_dot2_f32_bf16 v46, v107, v36, v46
v_dot2_f32_bf16 v47, v107, v37, v47
s_waitcnt vmcnt(12)
v_dot2_f32_bf16 v40, v108, v36, v40
v_dot2_f32_bf16 v41, v108, v37, v41
v_dot2_f32_bf16 v42, v109, v36, v42
v_dot2_f32_bf16 v43, v109, v37, v43
v_dot2_f32_bf16 v44, v110, v36, v44
v_dot2_f32_bf16 v45, v110, v37, v45
v_dot2_f32_bf16 v46, v111, v36, v46
v_dot2_f32_bf16 v47, v111, v37, v47
s_waitcnt vmcnt(11)
v_dot2_f32_bf16 v40, v112, v36, v40
v_dot2_f32_bf16 v41, v112, v37, v41
v_dot2_f32_bf16 v42, v113, v36, v42
v_dot2_f32_bf16 v43, v113, v37, v43
v_dot2_f32_bf16 v44, v114, v36, v44
v_dot2_f32_bf16 v45, v114, v37, v45
v_dot2_f32_bf16 v46, v115, v36, v46
v_dot2_f32_bf16 v47, v115, v37, v47
s_waitcnt vmcnt(10)
v_dot2_f32_bf16 v40, v116, v36, v40
v_dot2_f32_bf16 v41, v116, v37, v41
v_dot2_f32_bf16 v42, v117, v36, v42
v_dot2_f32_bf16 v43, v117, v37, v43
v_dot2_f32_bf16 v44, v118, v36, v44
v_dot2_f32_bf16 v45, v118, v37, v45
v_dot2_f32_bf16 v46, v119, v36, v46
v_dot2_f32_bf16 v47, v119, v37, v47
s_waitcnt vmcnt(9)
v_dot2_f32_bf16 v40, v120, v36, v40
v_dot2_f32_bf16 v41, v120, v37, v41
v_dot2_f32_bf16 v42, v121, v36, v42
v_dot2_f32_bf16 v43, v121, v37, v43
v_dot2_f32_bf16 v44, v122, v36, v44
v_dot2_f32_bf16 v45, v122, v37, v45
v_dot2_f32_bf16 v46, v123, v36, v46
v_dot2_f32_bf16 v47, v123, v37, v47
s_waitcnt vmcnt(8)
v_dot2_f32_bf16 v40, v124, v36, v40
v_dot2_f32_bf16 v41, v124, v37, v41
v_dot2_f32_bf16 v42, v125, v36, v42
v_dot2_f32_bf16 v43, v125, v37, v43
v_dot2_f32_bf16 v44, v126, v36, v44
v_dot2_f32_bf16 v45, v126, v37, v45
v_dot2_f32_bf16 v46, v127, v36, v46
v_dot2_f32_bf16 v47, v127, v37, v47
s_waitcnt vmcnt(7)
v_dot2_f32_bf16 v40, v128, v36, v40
v_dot2_f32_bf16 v41, v128, v37, v41
v_dot2_f32_bf16 v42, v129, v36, v42
v_dot2_f32_bf16 v43, v129, v37, v43
v_dot2_f32_bf16 v44, v130, v36, v44
v_dot2_f32_bf16 v45, v130, v37, v45
v_dot2_f32_bf16 v46, v131, v36, v46
v_dot2_f32_bf16 v47, v131, v37, v47
s_waitcnt vmcnt(6)
v_dot2_f32_bf16 v40, v132, v36, v40
v_dot2_f32_bf16 v41, v132, v37, v41
v_dot2_f32_bf16 v42, v133, v36, v42
v_dot2_f32_bf16 v43, v133, v37, v43
v_dot2_f32_bf16 v44, v134, v36, v44
v_dot2_f32_bf16 v45, v134, v37, v45
v_dot2_f32_bf16 v46, v135, v36, v46
v_dot2_f32_bf16 v47, v135, v37, v47
s_waitcnt vmcnt(5)
v_dot2_f32_bf16 v40, v136, v36, v40
v_dot2_f32_bf16 v41, v136, v37, v41
v_dot2_f32_bf16 v42, v137, v36, v42
v_dot2_f32_bf16 v43, v137, v37, v43
v_dot2_f32_bf16 v44, v138, v36, v44
v_dot2_f32_bf16 v45, v138, v37, v45
v_dot2_f32_bf16 v46, v139, v36, v46
v_dot2_f32_bf16 v47, v139, v37, v47
s_waitcnt vmcnt(4)
v_dot2_f32_bf16 v40, v140, v36, v40
v_dot2_f32_bf16 v41, v140, v37, v41
v_dot2_f32_bf16 v42, v141, v36, v42
v_dot2_f32_bf16 v43, v141, v37, v43
v_dot2_f32_bf16 v44, v142, v36, v44
v_dot2_f32_bf16 v45, v142, v37, v45
v_dot2_f32_bf16 v46, v143, v36, v46
v_dot2_f32_bf16 v47, v143, v37, v47
s_waitcnt vmcnt(3)
v_dot2_f32_bf16 v40, v144, v36, v40
v_dot2_f32_bf16 v41, v144, v37, v41
v_dot2_f32_bf16 v42, v145, v36, v42
v_dot2_f32_bf16 v43, v145, v37, v43
v_dot2_f32_bf16 v44, v146, v36, v44
v_dot2_f32_bf16 v45, v146, v37, v45
v_dot2_f32_bf16 v46, v147, v36, v46
v_dot2_f32_bf16 v47, v147, v37, v47
s_waitcnt vmcnt(2)
v_dot2_f32_bf16 v40, v148, v36, v40
v_dot2_f32_bf16 v41, v148, v37, v41
v_dot2_f32_bf16 v42, v149, v36, v42
v_dot2_f32_bf16 v43, v149, v37, v43
v_dot2_f32_bf16 v44, v150, v36, v44
v_dot2_f32_bf16 v45, v150, v37, v45
v_dot2_f32_bf16 v46, v151, v36, v46
v_dot2_f32_bf16 v47, v151, v37, v47
s_waitcnt vmcnt(1)
v_dot2_f32_bf16 v40, v152, v36, v40
v_dot2_f32_bf16 v41, v152, v37, v41
v_dot2_f32_bf16 v42, v153, v36, v42
v_dot2_f32_bf16 v43, v153, v37, v43
v_dot2_f32_bf16 v44, v154, v36, v44
v_dot2_f32_bf16 v45, v154, v37, v45
v_dot2_f32_bf16 v46, v155, v36, v46
v_dot2_f32_bf16 v47, v155, v37, v47
s_waitcnt vmcnt(0)
v_dot2_f32_bf16 v40, v156, v36, v40
v_dot2_f32_bf16 v41, v156, v37, v41
v_dot2_f32_bf16 v42, v157, v36, v42
v_dot2_f32_bf16 v43, v157, v37, v43
v_dot2_f32_bf16 v44, v158, v36, v44
v_dot2_f32_bf16 v45, v158, v37, v45
v_dot2_f32_bf16 v46, v159, v36, v46
v_dot2_f32_bf16 v47, v159, v37, v47
s_nop 2
v_cvt_pk_bf16_f32 v48, v40, v41
v_cvt_pk_bf16_f32 v49, v42, v43
v_cvt_pk_bf16_f32 v50, v44, v45
v_cvt_pk_bf16_f32 v51, v46, v47
buffer_store_dwordx2 v[48:49], v34, s[12:15], 0 offen
buffer_store_dwordx2 v[50:51], v35, s[12:15], 0 offen
L_end:
s_endpgm
L_loader:
v_and_b32 v52, 7, v0
v_lshrrev_b32 v53, 4, v0
v_lshlrev_b32 v53, 1, v53
v_xor_b32 v52, v52, v53
v_lshrrev_b32 v53, 3, v0
v_mul_u32_u24 v53, 896, v53
v_lshl_add_u32 v240, v52, 4, v53
v_add_u32 v241, 6112, v240
v_add_u32 v242, 12224, v240
v_add_u32 v243, 18336, v240
s_mul_i32 s35, s33, 28672
v_lshlrev_b32 v62, 7, v0
buffer_load_dword v63, v62, s[56:59], s35 offen
s_add_u32 s35, s35, 8192
buffer_load_dword v63, v62, s[56:59], s35 offen
s_add_u32 s35, s35, 8192
buffer_load_dword v63, v62, s[56:59], s35 offen
s_add_u32 s35, s35, 8192
buffer_load_dword v63, v62, s[56:59], s35 offen
s_add_u32 s35, s35, 8192
s_mov_b32 s64, 67584
s_mov_b32 s65, 49152
s_mov_b32 s66, 16384
s_mov_b32 s68, 0
s_waitcnt vmcnt(4)
s_barrier
s_waitcnt vmcnt(20)
s_mov_b32 m0, s64
s_add_u32 s64, s64, 16896
buffer_load_dwordx4 v252, s[48:51], s66 offen offset:0 nt lds
buffer_load_dwordx4 v253, s[48:51], s66 offen offset:1056 nt lds
buffer_load_dwordx4 v254, s[48:51], s66 offen offset:2112 nt lds
buffer_load_dwordx4 v255, s[48:51], s66 offen offset:3168 nt lds
s_add_u32 m0, m0, 4224
s_add_u32 s66, s66, 4096
s_waitcnt vmcnt(20)
buffer_load_dwordx4 v252, s[48:51], s66 offen offset:0 nt lds
buffer_load_dwordx4 v253, s[48:51], s66 offen offset:1056 nt lds
buffer_load_dwordx4 v254, s[48:51], s66 offen offset:2112 nt lds
buffer_load_dwordx4 v255, s[48:51], s66 offen offset:3168 nt lds
s_add_u32 m0, m0, 4224
s_add_u32 s66, s66, 4096
s_waitcnt vmcnt(20)
buffer_load_dwordx4 v252, s[48:51], s66 offen offset:0 nt lds
buffer_load_dwordx4 v253, s[48:51], s66 offen offset:1056 nt lds
buffer_load_dwordx4 v254, s[48:51], s66 offen offset:2112 nt lds
buffer_load_dwordx4 v255, s[48:51], s66 offen offset:3168 nt lds
s_add_u32 m0, m0, 4224
s_add_u32 s66, s66, 4096
s_waitcnt vmcnt(20)
buffer_load_dwordx4 v252, s[48:51], s66 offen offset:0 nt lds
buffer_load_dwordx4 v253, s[48:51], s66 offen offset:1056 nt lds
buffer_load_dwordx4 v254, s[48:51], s66 offen offset:2112 nt lds
buffer_load_dwordx4 v255, s[48:51], s66 offen offset:3168 nt lds
s_add_u32 s66, s66, 4096
s_cmp_eq_u32 s64, 152064
s_cselect_b32 s64, 0, s64
s_waitcnt vmcnt(20)
s_mov_b32 m0, s64
s_add_u32 s64, s64, 16896
buffer_load_dwordx4 v248, s[44:47], s65 offen offset:0 nt lds
buffer_load_dwordx4 v249, s[44:47], s65 offen offset:1056 nt lds
buffer_load_dwordx4 v250, s[44:47], s65 offen offset:2112 nt lds
buffer_load_dwordx4 v251, s[44:47], s65 offen offset:3168 nt lds
s_add_u32 m0, m0, 4224
s_add_u32 s65, s65, 4096
s_waitcnt vmcnt(20)
buffer_load_dwordx4 v248, s[44:47], s65 offen offset:0 nt lds
buffer_load_dwordx4 v249, s[44:47], s65 offen offset:1056 nt lds
buffer_load_dwordx4 v250, s[44:47], s65 offen offset:2112 nt lds
buffer_load_dwordx4 v251, s[44:47], s65 offen offset:3168 nt lds
s_add_u32 m0, m0, 4224
s_add_u32 s65, s65, 4096
s_waitcnt vmcnt(20)
buffer_load_dwordx4 v248, s[44:47], s65 offen offset:0 nt lds
buffer_load_dwordx4 v249, s[44:47], s65 offen offset:1056 nt lds
buffer_load_dwordx4 v250, s[44:47], s65 offen offset:2112 nt lds
buffer_load_dwordx4 v251, s[44:47], s65 offen offset:3168 nt lds
s_add_u32 m0, m0, 4224
s_add_u32 s65, s65, 4096
s_waitcnt vmcnt(20)
buffer_load_dwordx4 v248, s[44:47], s65 offen offset:0 nt lds
buffer_load_dwordx4 v249, s[44:47], s65 offen offset:1056 nt lds
buffer_load_dwordx4 v250, s[44:47], s65 offen offset:2112 nt lds
buffer_load_dwordx4 v251, s[44:47], s65 offen offset:3168 nt lds
s_add_u32 s65, s65, 4096
s_cmp_eq_u32 s64, 152064
s_cselect_b32 s64, 0, s64
s_waitcnt vmcnt(16)
s_barrier
s_mov_b32 s69, 28
L_ld:
s_waitcnt vmcnt(20)
s_mov_b32 m0, s64
s_add_u32 s64, s64, 16896
buffer_load_dwordx4 v252, s[48:51], s66 offen offset:0 nt lds
buffer_load_dwordx4 v253, s[48:51], s66 offen offset:1056 nt lds
buffer_load_dwordx4 v254, s[48:51], s66 offen offset:2112 nt lds
buffer_load_dwordx4 v255, s[48:51], s66 offen offset:3168 nt lds
s_add_u32 m0, m0, 4224
s_add_u32 s66, s66, 4096
s_waitcnt vmcnt(20)
buffer_load_dwordx4 v252, s[48:51], s66 offen offset:0 nt lds
buffer_load_dwordx4 v253, s[48:51], s66 offen offset:1056 nt lds
buffer_load_dwordx4 v254, s[48:51], s66 offen offset:2112 nt lds
buffer_load_dwordx4 v255, s[48:51], s66 offen offset:3168 nt lds
s_add_u32 m0, m0, 4224
s_add_u32 s66, s66, 4096
s_waitcnt vmcnt(20)
buffer_load_dwordx4 v252, s[48:51], s66 offen offset:0 nt lds
buffer_load_dwordx4 v253, s[48:51], s66 offen offset:1056 nt lds
buffer_load_dwordx4 v254, s[48:51], s66 offen offset:2112 nt lds
buffer_load_dwordx4 v255, s[48:51], s66 offen offset:3168 nt lds
s_add_u32 m0, m0, 4224
s_add_u32 s66, s66, 4096
s_waitcnt vmcnt(20)
buffer_load_dwordx4 v252, s[48:51], s66 offen offset:0 nt lds
buffer_load_dwordx4 v253, s[48:51], s66 offen offset:1056 nt lds
buffer_load_dwordx4 v254, s[48:51], s66 offen offset:2112 nt lds
buffer_load_dwordx4 v255, s[48:51], s66 offen offset:3168 nt lds
s_add_u32 s66, s66, 4096
s_cmp_eq_u32 s64, 152064
s_cselect_b32 s64, 0, s64
s_waitcnt vmcnt(20)
s_mov_b32 m0, s64
s_add_u32 s64, s64, 16896
buffer_load_dwordx4 v248, s[44:47], s65 offen offset:0 nt lds
buffer_load_dwordx4 v249, s[44:47], s65 offen offset:1056 nt lds
buffer_load_dwordx4 v250, s[44:47], s65 offen offset:2112 nt lds
buffer_load_dwordx4 v251, s[44:47], s65 offen offset:3168 nt lds
s_add_u32 m0, m0, 4224
s_add_u32 s65, s65, 4096
s_waitcnt vmcnt(20)
buffer_load_dwordx4 v248, s[44:47], s65 offen offset:0 nt lds
buffer_load_dwordx4 v249, s[44:47], s65 offen offset:1056 nt lds
buffer_load_dwordx4 v250, s[44:47], s65 offen offset:2112 nt lds
buffer_load_dwordx4 v251, s[44:47], s65 offen offset:3168 nt lds
s_add_u32 m0, m0, 4224
s_add_u32 s65, s65, 4096
s_waitcnt vmcnt(20)
buffer_load_dwordx4 v248, s[44:47], s65 offen offset:0 nt lds
buffer_load_dwordx4 v249, s[44:47], s65 offen offset:1056 nt lds
buffer_load_dwordx4 v250, s[44:47], s65 offen offset:2112 nt lds
buffer_load_dwordx4 v251, s[44:47], s65 offen offset:3168 nt lds
s_add_u32 m0, m0, 4224
s_add_u32 s65, s65, 4096
s_waitcnt vmcnt(20)
buffer_load_dwordx4 v248, s[44:47], s65 offen offset:0 nt lds
buffer_load_dwordx4 v249, s[44:47], s65 offen offset:1056 nt lds
buffer_load_dwordx4 v250, s[44:47], s65 offen offset:2112 nt lds
buffer_load_dwordx4 v251, s[44:47], s65 offen offset:3168 nt lds
s_add_u32 s65, s65, 4096
s_cmp_eq_u32 s64, 152064
s_cselect_b32 s64, 0, s64
s_waitcnt vmcnt(16)
s_barrier
s_sub_u32 s69, s69, 1
s_cmp_lg_u32 s69, 0
s_cbranch_scc1 L_ld
s_waitcnt vmcnt(20)
s_mov_b32 m0, s64
s_add_u32 s64, s64, 16896
buffer_load_dwordx4 v252, s[48:51], s66 offen offset:0 nt lds
buffer_load_dwordx4 v253, s[48:51], s66 offen offset:1056 nt lds
buffer_load_dwordx4 v254, s[48:51], s66 offen offset:2112 nt lds
buffer_load_dwordx4 v255, s[48:51], s66 offen offset:3168 nt lds
s_add_u32 m0, m0, 4224
s_add_u32 s66, s66, 4096
s_waitcnt vmcnt(20)
buffer_load_dwordx4 v252, s[48:51], s66 offen offset:0 nt lds
buffer_load_dwordx4 v253, s[48:51], s66 offen offset:1056 nt lds
buffer_load_dwordx4 v254, s[48:51], s66 offen offset:2112 nt lds
buffer_load_dwordx4 v255, s[48:51], s66 offen offset:3168 nt lds
s_add_u32 m0, m0, 4224
s_add_u32 s66, s66, 4096
s_waitcnt vmcnt(20)
buffer_load_dwordx4 v252, s[48:51], s66 offen offset:0 nt lds
buffer_load_dwordx4 v253, s[48:51], s66 offen offset:1056 nt lds
buffer_load_dwordx4 v254, s[48:51], s66 offen offset:2112 nt lds
buffer_load_dwordx4 v255, s[48:51], s66 offen offset:3168 nt lds
s_add_u32 m0, m0, 4224
s_add_u32 s66, s66, 4096
s_waitcnt vmcnt(20)
buffer_load_dwordx4 v252, s[48:51], s66 offen offset:0 nt lds
buffer_load_dwordx4 v253, s[48:51], s66 offen offset:1056 nt lds
buffer_load_dwordx4 v254, s[48:51], s66 offen offset:2112 nt lds
buffer_load_dwordx4 v255, s[48:51], s66 offen offset:3168 nt lds
s_add_u32 s66, s66, 4096
s_cmp_eq_u32 s64, 152064
s_cselect_b32 s64, 0, s64
s_waitcnt vmcnt(20)
s_mov_b32 m0, s64
s_add_u32 s64, s64, 16896
buffer_load_dwordx4 v252, s[48:51], s66 offen offset:0 nt lds
buffer_load_dwordx4 v253, s[48:51], s66 offen offset:1056 nt lds
buffer_load_dwordx4 v254, s[48:51], s66 offen offset:2112 nt lds
buffer_load_dwordx4 v255, s[48:51], s66 offen offset:3168 nt lds
s_add_u32 m0, m0, 4224
s_add_u32 s66, s66, 4096
s_waitcnt vmcnt(20)
buffer_load_dwordx4 v252, s[48:51], s66 offen offset:0 nt lds
buffer_load_dwordx4 v253, s[48:51], s66 offen offset:1056 nt lds
buffer_load_dwordx4 v254, s[48:51], s66 offen offset:2112 nt lds
buffer_load_dwordx4 v255, s[48:51], s66 offen offset:3168 nt lds
s_add_u32 m0, m0, 4224
s_add_u32 s66, s66, 4096
s_waitcnt vmcnt(20)
buffer_load_dwordx4 v252, s[48:51], s66 offen offset:0 nt lds
buffer_load_dwordx4 v253, s[48:51], s66 offen offset:1056 nt lds
buffer_load_dwordx4 v254, s[48:51], s66 offen offset:2112 nt lds
buffer_load_dwordx4 v255, s[48:51], s66 offen offset:3168 nt lds
s_add_u32 m0, m0, 4224
s_add_u32 s66, s66, 4096
s_waitcnt vmcnt(20)
buffer_load_dwordx4 v252, s[48:51], s66 offen offset:0 nt lds
buffer_load_dwordx4 v253, s[48:51], s66 offen offset:1056 nt lds
buffer_load_dwordx4 v254, s[48:51], s66 offen offset:2112 nt lds
buffer_load_dwordx4 v255, s[48:51], s66 offen offset:3168 nt lds
s_add_u32 s66, s66, 4096
s_cmp_eq_u32 s64, 152064
s_cselect_b32 s64, 0, s64
s_waitcnt vmcnt(16)
s_barrier
s_waitcnt vmcnt(20)
s_mov_b32 m0, s64
s_add_u32 s64, s64, 16896
buffer_load_dwordx4 v240, s[56:59], s68 offen offset:0 lds
buffer_load_dwordx4 v241, s[56:59], s68 offen offset:1056 lds
buffer_load_dwordx4 v242, s[56:59], s68 offen offset:2112 lds
buffer_load_dwordx4 v243, s[56:59], s68 offen offset:3168 lds
s_add_u32 m0, m0, 4224
s_add_u32 s68, s68, 28672
s_waitcnt vmcnt(20)
buffer_load_dwordx4 v240, s[56:59], s68 offen offset:0 lds
buffer_load_dwordx4 v241, s[56:59], s68 offen offset:1056 lds
buffer_load_dwordx4 v242, s[56:59], s68 offen offset:2112 lds
buffer_load_dwordx4 v243, s[56:59], s68 offen offset:3168 lds
s_add_u32 m0, m0, 4224
s_add_u32 s68, s68, 28672
s_waitcnt vmcnt(20)
buffer_load_dwordx4 v240, s[56:59], s68 offen offset:0 lds
buffer_load_dwordx4 v241, s[56:59], s68 offen offset:1056 lds
buffer_load_dwordx4 v242, s[56:59], s68 offen offset:2112 lds
buffer_load_dwordx4 v243, s[56:59], s68 offen offset:3168 lds
s_add_u32 m0, m0, 4224
s_add_u32 s68, s68, 28672
s_waitcnt vmcnt(20)
buffer_load_dwordx4 v240, s[56:59], s68 offen offset:0 lds
buffer_load_dwordx4 v241, s[56:59], s68 offen offset:1056 lds
buffer_load_dwordx4 v242, s[56:59], s68 offen offset:2112 lds
buffer_load_dwordx4 v243, s[56:59], s68 offen offset:3168 lds
s_add_u32 s68, s68, 28672
s_cmp_eq_u32 s64, 152064
s_cselect_b32 s64, 0, s64
s_waitcnt vmcnt(20)
s_mov_b32 m0, s64
s_add_u32 s64, s64, 16896
buffer_load_dwordx4 v240, s[56:59], s68 offen offset:0 lds
buffer_load_dwordx4 v241, s[56:59], s68 offen offset:1056 lds
buffer_load_dwordx4 v242, s[56:59], s68 offen offset:2112 lds
buffer_load_dwordx4 v243, s[56:59], s68 offen offset:3168 lds
s_add_u32 m0, m0, 4224
s_add_u32 s68, s68, 28672
s_waitcnt vmcnt(20)
buffer_load_dwordx4 v240, s[56:59], s68 offen offset:0 lds
buffer_load_dwordx4 v241, s[56:59], s68 offen offset:1056 lds
buffer_load_dwordx4 v242, s[56:59], s68 offen offset:2112 lds
buffer_load_dwordx4 v243, s[56:59], s68 offen offset:3168 lds
s_add_u32 m0, m0, 4224
s_add_u32 s68, s68, 28672
s_waitcnt vmcnt(20)
buffer_load_dwordx4 v240, s[56:59], s68 offen offset:0 lds
buffer_load_dwordx4 v241, s[56:59], s68 offen offset:1056 lds
buffer_load_dwordx4 v242, s[56:59], s68 offen offset:2112 lds
buffer_load_dwordx4 v243, s[56:59], s68 offen offset:3168 lds
s_add_u32 m0, m0, 4224
s_add_u32 s68, s68, 28672
s_waitcnt vmcnt(20)
buffer_load_dwordx4 v240, s[56:59], s68 offen offset:0 lds
buffer_load_dwordx4 v241, s[56:59], s68 offen offset:1056 lds
buffer_load_dwordx4 v242, s[56:59], s68 offen offset:2112 lds
buffer_load_dwordx4 v243, s[56:59], s68 offen offset:3168 lds
s_add_u32 s68, s68, 28672
s_cmp_eq_u32 s64, 152064
s_cselect_b32 s64, 0, s64
s_sub_u32 s68, s68, 229248
s_waitcnt vmcnt(32)
s_barrier
s_waitcnt vmcnt(20)
s_mov_b32 m0, s64
s_add_u32 s64, s64, 16896
buffer_load_dwordx4 v240, s[56:59], s68 offen offset:0 lds
buffer_load_dwordx4 v241, s[56:59], s68 offen offset:1056 lds
buffer_load_dwordx4 v242, s[56:59], s68 offen offset:2112 lds
buffer_load_dwordx4 v243, s[56:59], s68 offen offset:3168 lds
s_add_u32 m0, m0, 4224
s_add_u32 s68, s68, 28672
s_waitcnt vmcnt(20)
buffer_load_dwordx4 v240, s[56:59], s68 offen offset:0 lds
buffer_load_dwordx4 v241, s[56:59], s68 offen offset:1056 lds
buffer_load_dwordx4 v242, s[56:59], s68 offen offset:2112 lds
buffer_load_dwordx4 v243, s[56:59], s68 offen offset:3168 lds
s_add_u32 m0, m0, 4224
s_add_u32 s68, s68, 28672
s_waitcnt vmcnt(20)
buffer_load_dwordx4 v240, s[56:59], s68 offen offset:0 lds
buffer_load_dwordx4 v241, s[56:59], s68 offen offset:1056 lds
buffer_load_dwordx4 v242, s[56:59], s68 offen offset:2112 lds
buffer_load_dwordx4 v243, s[56:59], s68 offen offset:3168 lds
s_add_u32 m0, m0, 4224
s_add_u32 s68, s68, 28672
s_waitcnt vmcnt(20)
buffer_load_dwordx4 v240, s[56:59], s68 offen offset:0 lds
buffer_load_dwordx4 v241, s[56:59], s68 offen offset:1056 lds
buffer_load_dwordx4 v242, s[56:59], s68 offen offset:2112 lds
buffer_load_dwordx4 v243, s[56:59], s68 offen offset:3168 lds
s_add_u32 s68, s68, 28672
s_cmp_eq_u32 s64, 152064
s_cselect_b32 s64, 0, s64
s_waitcnt vmcnt(20)
s_mov_b32 m0, s64
s_add_u32 s64, s64, 16896
buffer_load_dwordx4 v240, s[56:59], s68 offen offset:0 lds
buffer_load_dwordx4 v241, s[56:59], s68 offen offset:1056 lds
buffer_load_dwordx4 v242, s[56:59], s68 offen offset:2112 lds
buffer_load_dwordx4 v243, s[56:59], s68 offen offset:3168 lds
s_add_u32 m0, m0, 4224
s_add_u32 s68, s68, 28672
s_waitcnt vmcnt(20)
buffer_load_dwordx4 v240, s[56:59], s68 offen offset:0 lds
buffer_load_dwordx4 v241, s[56:59], s68 offen offset:1056 lds
buffer_load_dwordx4 v242, s[56:59], s68 offen offset:2112 lds
buffer_load_dwordx4 v243, s[56:59], s68 offen offset:3168 lds
s_add_u32 m0, m0, 4224
s_add_u32 s68, s68, 28672
s_waitcnt vmcnt(20)
buffer_load_dwordx4 v240, s[56:59], s68 offen offset:0 lds
buffer_load_dwordx4 v241, s[56:59], s68 offen offset:1056 lds
buffer_load_dwordx4 v242, s[56:59], s68 offen offset:2112 lds
buffer_load_dwordx4 v243, s[56:59], s68 offen offset:3168 lds
s_add_u32 m0, m0, 4224
s_add_u32 s68, s68, 28672
s_waitcnt vmcnt(20)
buffer_load_dwordx4 v240, s[56:59], s68 offen offset:0 lds
buffer_load_dwordx4 v241, s[56:59], s68 offen offset:1056 lds
buffer_load_dwordx4 v242, s[56:59], s68 offen offset:2112 lds
buffer_load_dwordx4 v243, s[56:59], s68 offen offset:3168 lds
s_add_u32 s68, s68, 28672
s_cmp_eq_u32 s64, 152064
s_cselect_b32 s64, 0, s64
L_ld_done:
s_waitcnt vmcnt(0)
s_branch L_join
L_slow0:
s_cselect_b32 s35, 1, 0
s_call_b64 s[74:75], L_fix1
v_sub_f32 v112, v112, v196
v_sub_f32 v113, v113, v196
v_sub_f32 v114, v114, v196
v_sub_f32 v115, v115, v196
v_sub_f32 v124, v124, v196
v_sub_f32 v125, v125, v196
v_sub_f32 v126, v126, v196
v_sub_f32 v127, v127, v196
v_sub_f32 v116, v116, v197
v_sub_f32 v117, v117, v197
v_sub_f32 v118, v118, v197
v_sub_f32 v119, v119, v197
v_sub_f32 v128, v128, v197
v_sub_f32 v129, v129, v197
v_sub_f32 v130, v130, v197
v_sub_f32 v131, v131, v197
v_sub_f32 v120, v120, v198
v_sub_f32 v121, v121, v198
v_sub_f32 v122, v122, v198
v_sub_f32 v123, v123, v198
v_sub_f32 v132, v132, v198
v_sub_f32 v133, v133, v198
v_sub_f32 v134, v134, v198
v_sub_f32 v135, v135, v198
v_exp_f32 v136, v208
v_exp_f32 v137, v209
v_exp_f32 v138, v210
v_exp_f32 v139, v211
v_exp_f32 v140, v212
v_exp_f32 v141, v213
v_exp_f32 v142, v214
v_exp_f32 v143, v215
v_exp_f32 v144, v216
v_exp_f32 v145, v217
v_exp_f32 v146, v218
v_exp_f32 v147, v219
v_exp_f32 v148, v220
v_exp_f32 v149, v221
v_exp_f32 v150, v222
v_exp_f32 v151, v223
v_exp_f32 v152, v224
v_exp_f32 v153, v225
v_exp_f32 v154, v226
v_exp_f32 v155, v227
v_exp_f32 v156, v228
v_exp_f32 v157, v229
v_exp_f32 v158, v230
v_exp_f32 v159, v231
s_nop 0
v_cvt_pk_bf16_f32 v160, v136, v137
v_add_f32 v235, v136, v137
v_cvt_pk_bf16_f32 v161, v138, v139
v_add_f32 v235, v235, v138
v_add_f32 v235, v235, v139
v_cvt_pk_bf16_f32 v164, v140, v141
v_add_f32 v236, v140, v141
v_cvt_pk_bf16_f32 v165, v142, v143
v_add_f32 v236, v236, v142
v_add_f32 v236, v236, v143
v_cvt_pk_bf16_f32 v168, v144, v145
v_add_f32 v237, v144, v145
v_cvt_pk_bf16_f32 v169, v146, v147
v_add_f32 v237, v237, v146
v_add_f32 v237, v237, v147
v_cvt_pk_bf16_f32 v162, v148, v149
v_add_f32 v235, v235, v148
v_add_f32 v235, v235, v149
v_cvt_pk_bf16_f32 v163, v150, v151
v_add_f32 v235, v235, v150
v_add_f32 v235, v235, v151
v_cvt_pk_bf16_f32 v166, v152, v153
v_add_f32 v236, v236, v152
v_add_f32 v236, v236, v153
v_cvt_pk_bf16_f32 v167, v154, v155
v_add_f32 v236, v236, v154
v_add_f32 v236, v236, v155
v_cvt_pk_bf16_f32 v170, v156, v157
v_add_f32 v237, v237, v156
v_add_f32 v237, v237, v157
v_cvt_pk_bf16_f32 v171, v158, v159
v_add_f32 v237, v237, v158
v_add_f32 v237, v237, v159
s_cmp_eq_u32 s35, 1
s_nop 0
s_branch L_back0
L_slow1:
s_cselect_b32 s35, 1, 0
s_call_b64 s[74:75], L_fix0
v_sub_f32 v208, v208, v196
v_sub_f32 v209, v209, v196
v_sub_f32 v210, v210, v196
v_sub_f32 v211, v211, v196
v_sub_f32 v220, v220, v196
v_sub_f32 v221, v221, v196
v_sub_f32 v222, v222, v196
v_sub_f32 v223, v223, v196
v_sub_f32 v212, v212, v197
v_sub_f32 v213, v213, v197
v_sub_f32 v214, v214, v197
v_sub_f32 v215, v215, v197
v_sub_f32 v224, v224, v197
v_sub_f32 v225, v225, v197
v_sub_f32 v226, v226, v197
v_sub_f32 v227, v227, v197
v_sub_f32 v216, v216, v198
v_sub_f32 v217, v217, v198
v_sub_f32 v218, v218, v198
v_sub_f32 v219, v219, v198
v_sub_f32 v228, v228, v198
v_sub_f32 v229, v229, v198
v_sub_f32 v230, v230, v198
v_sub_f32 v231, v231, v198
v_exp_f32 v136, v112
v_exp_f32 v137, v113
v_exp_f32 v138, v114
v_exp_f32 v139, v115
v_exp_f32 v140, v116
v_exp_f32 v141, v117
v_exp_f32 v142, v118
v_exp_f32 v143, v119
v_exp_f32 v144, v120
v_exp_f32 v145, v121
v_exp_f32 v146, v122
v_exp_f32 v147, v123
v_exp_f32 v148, v124
v_exp_f32 v149, v125
v_exp_f32 v150, v126
v_exp_f32 v151, v127
v_exp_f32 v152, v128
v_exp_f32 v153, v129
v_exp_f32 v154, v130
v_exp_f32 v155, v131
v_exp_f32 v156, v132
v_exp_f32 v157, v133
v_exp_f32 v158, v134
v_exp_f32 v159, v135
s_nop 0
v_cvt_pk_bf16_f32 v172, v136, v137
v_add_f32 v235, v136, v137
v_cvt_pk_bf16_f32 v173, v138, v139
v_add_f32 v235, v235, v138
v_add_f32 v235, v235, v139
v_cvt_pk_bf16_f32 v176, v140, v141
v_add_f32 v236, v140, v141
v_cvt_pk_bf16_f32 v177, v142, v143
v_add_f32 v236, v236, v142
v_add_f32 v236, v236, v143
v_cvt_pk_bf16_f32 v180, v144, v145
v_add_f32 v237, v144, v145
v_cvt_pk_bf16_f32 v181, v146, v147
v_add_f32 v237, v237, v146
v_add_f32 v237, v237, v147
v_cvt_pk_bf16_f32 v174, v148, v149
v_add_f32 v235, v235, v148
v_add_f32 v235, v235, v149
v_cvt_pk_bf16_f32 v175, v150, v151
v_add_f32 v235, v235, v150
v_add_f32 v235, v235, v151
v_cvt_pk_bf16_f32 v178, v152, v153
v_add_f32 v236, v236, v152
v_add_f32 v236, v236, v153
v_cvt_pk_bf16_f32 v179, v154, v155
v_add_f32 v236, v236, v154
v_add_f32 v236, v236, v155
v_cvt_pk_bf16_f32 v182, v156, v157
v_add_f32 v237, v237, v156
v_add_f32 v237, v237, v157
v_cvt_pk_bf16_f32 v183, v158, v159
v_add_f32 v237, v237, v158
v_add_f32 v237, v237, v159
s_cmp_eq_u32 s35, 1
s_nop 0
s_branch L_back1
L_slowx:
s_cselect_b32 s35, 1, 0
s_call_b64 s[74:75], L_fix0
v_exp_f32 v136, v112
v_exp_f32 v137, v113
v_exp_f32 v138, v114
v_exp_f32 v139, v115
v_exp_f32 v140, v116
v_exp_f32 v141, v117
v_exp_f32 v142, v118
v_exp_f32 v143, v119
v_exp_f32 v144, v120
v_exp_f32 v145, v121
v_exp_f32 v146, v122
v_exp_f32 v147, v123
v_exp_f32 v148, v124
v_exp_f32 v149, v125
v_exp_f32 v150, v126
v_exp_f32 v151, v127
v_exp_f32 v152, v128
v_exp_f32 v153, v129
v_exp_f32 v154, v130
v_exp_f32 v155, v131
v_exp_f32 v156, v132
v_exp_f32 v157, v133
v_exp_f32 v158, v134
v_exp_f32 v159, v135
s_nop 0
v_cvt_pk_bf16_f32 v172, v136, v137
v_add_f32 v235, v136, v137
v_cvt_pk_bf16_f32 v173, v138, v139
v_add_f32 v235, v235, v138
v_add_f32 v235, v235, v139
v_cvt_pk_bf16_f32 v176, v140, v141
v_add_f32 v236, v140, v141
v_cvt_pk_bf16_f32 v177, v142, v143
v_add_f32 v236, v236, v142
v_add_f32 v236, v236, v143
v_cvt_pk_bf16_f32 v180, v144, v145
v_add_f32 v237, v144, v145
v_cvt_pk_bf16_f32 v181, v146, v147
v_add_f32 v237, v237, v146
v_add_f32 v237, v237, v147
v_cvt_pk_bf16_f32 v174, v148, v149
v_add_f32 v235, v235, v148
v_add_f32 v235, v235, v149
v_cvt_pk_bf16_f32 v175, v150, v151
v_add_f32 v235, v235, v150
v_add_f32 v235, v235, v151
v_cvt_pk_bf16_f32 v178, v152, v153
v_add_f32 v236, v236, v152
v_add_f32 v236, v236, v153
v_cvt_pk_bf16_f32 v179, v154, v155
v_add_f32 v236, v236, v154
v_add_f32 v236, v236, v155
v_cvt_pk_bf16_f32 v182, v156, v157
v_add_f32 v237, v237, v156
v_add_f32 v237, v237, v157
v_cvt_pk_bf16_f32 v183, v158, v159
v_add_f32 v237, v237, v158
v_add_f32 v237, v237, v159
s_cmp_eq_u32 s35, 1
s_nop 0
s_branch L_backx
L_fix0:
s_nop 15
v_max3_f32 v196, v112, v113, v114
v_max3_f32 v196, v196, v115, v124
v_max3_f32 v196, v196, v125, v126
v_max_f32 v196, v196, v127
v_max3_f32 v197, v116, v117, v118
v_max3_f32 v197, v197, v119, v128
v_max3_f32 v197, v197, v129, v130
v_max_f32 v197, v197, v131
v_max3_f32 v198, v120, v121, v122
v_max3_f32 v198, v198, v123, v132
v_max3_f32 v198, v198, v133, v134
v_max_f32 v198, v198, v135
v_mov_b32 v199, v196
v_mov_b32 v200, v197
v_mov_b32 v201, v198
s_nop 1
v_permlane16_swap_b32 v196, v199
v_permlane16_swap_b32 v197, v200
v_permlane16_swap_b32 v198, v201
s_nop 1
v_max_f32 v196, v196, v199
v_max_f32 v197, v197, v200
v_max_f32 v198, v198, v201
v_mov_b32 v199, v196
v_mov_b32 v200, v197
v_mov_b32 v201, v198
s_nop 1
v_permlane32_swap_b32 v196, v199
v_permlane32_swap_b32 v197, v200
v_permlane32_swap_b32 v198, v201
s_nop 1
v_max_f32 v196, v196, v199
v_max_f32 v197, v197, v200
v_max_f32 v198, v198, v201
v_mov_b32 v202, 0x41000000
v_add_f32 v196, v196, v202
v_max_f32 v196, 0, v196
v_exp_f32 v199, -v196
v_sub_f32 v184, v184, v196
v_sub_f32 v185, v185, v196
v_sub_f32 v186, v186, v196
v_sub_f32 v187, v187, v196
v_sub_f32 v112, v112, v196
v_sub_f32 v113, v113, v196
v_sub_f32 v114, v114, v196
v_sub_f32 v115, v115, v196
v_sub_f32 v124, v124, v196
v_sub_f32 v125, v125, v196
v_sub_f32 v126, v126, v196
v_sub_f32 v127, v127, v196
v_mul_f32 v232, v199, v232
v_add_f32 v197, v197, v202
v_max_f32 v197, 0, v197
v_exp_f32 v200, -v197
v_sub_f32 v188, v188, v197
v_sub_f32 v189, v189, v197
v_sub_f32 v190, v190, v197
v_sub_f32 v191, v191, v197
v_sub_f32 v116, v116, v197
v_sub_f32 v117, v117, v197
v_sub_f32 v118, v118, v197
v_sub_f32 v119, v119, v197
v_sub_f32 v128, v128, v197
v_sub_f32 v129, v129, v197
v_sub_f32 v130, v130, v197
v_sub_f32 v131, v131, v197
v_mul_f32 v233, v200, v233
v_add_f32 v198, v198, v202
v_max_f32 v198, 0, v198
v_exp_f32 v201, -v198
v_sub_f32 v192, v192, v198
v_sub_f32 v193, v193, v198
v_sub_f32 v194, v194, v198
v_sub_f32 v195, v195, v198
v_sub_f32 v120, v120, v198
v_sub_f32 v121, v121, v198
v_sub_f32 v122, v122, v198
v_sub_f32 v123, v123, v198
v_sub_f32 v132, v132, v198
v_sub_f32 v133, v133, v198
v_sub_f32 v134, v134, v198
v_sub_f32 v135, v135, v198
v_mul_f32 v234, v201, v234
s_branch L_fixo
L_fix1:
s_nop 15
v_max3_f32 v196, v208, v209, v210
v_max3_f32 v196, v196, v211, v220
v_max3_f32 v196, v196, v221, v222
v_max_f32 v196, v196, v223
v_max3_f32 v197, v212, v213, v214
v_max3_f32 v197, v197, v215, v224
v_max3_f32 v197, v197, v225, v226
v_max_f32 v197, v197, v227
v_max3_f32 v198, v216, v217, v218
v_max3_f32 v198, v198, v219, v228
v_max3_f32 v198, v198, v229, v230
v_max_f32 v198, v198, v231
v_mov_b32 v199, v196
v_mov_b32 v200, v197
v_mov_b32 v201, v198
s_nop 1
v_permlane16_swap_b32 v196, v199
v_permlane16_swap_b32 v197, v200
v_permlane16_swap_b32 v198, v201
s_nop 1
v_max_f32 v196, v196, v199
v_max_f32 v197, v197, v200
v_max_f32 v198, v198, v201
v_mov_b32 v199, v196
v_mov_b32 v200, v197
v_mov_b32 v201, v198
s_nop 1
v_permlane32_swap_b32 v196, v199
v_permlane32_swap_b32 v197, v200
v_permlane32_swap_b32 v198, v201
s_nop 1
v_max_f32 v196, v196, v199
v_max_f32 v197, v197, v200
v_max_f32 v198, v198, v201
v_mov_b32 v202, 0x41000000
v_add_f32 v196, v196, v202
v_max_f32 v196, 0, v196
v_exp_f32 v199, -v196
v_sub_f32 v184, v184, v196
v_sub_f32 v185, v185, v196
v_sub_f32 v186, v186, v196
v_sub_f32 v187, v187, v196
v_sub_f32 v208, v208, v196
v_sub_f32 v209, v209, v196
v_sub_f32 v210, v210, v196
v_sub_f32 v211, v211, v196
v_sub_f32 v220, v220, v196
v_sub_f32 v221, v221, v196
v_sub_f32 v222, v222, v196
v_sub_f32 v223, v223, v196
v_mul_f32 v232, v199, v232
v_add_f32 v197, v197, v202
v_max_f32 v197, 0, v197
v_exp_f32 v200, -v197
v_sub_f32 v188, v188, v197
v_sub_f32 v189, v189, v197
v_sub_f32 v190, v190, v197
v_sub_f32 v191, v191, v197
v_sub_f32 v212, v212, v197
v_sub_f32 v213, v213, v197
v_sub_f32 v214, v214, v197
v_sub_f32 v215, v215, v197
v_sub_f32 v224, v224, v197
v_sub_f32 v225, v225, v197
v_sub_f32 v226, v226, v197
v_sub_f32 v227, v227, v197
v_mul_f32 v233, v200, v233
v_add_f32 v198, v198, v202
v_max_f32 v198, 0, v198
v_exp_f32 v201, -v198
v_sub_f32 v192, v192, v198
v_sub_f32 v193, v193, v198
v_sub_f32 v194, v194, v198
v_sub_f32 v195, v195, v198
v_sub_f32 v216, v216, v198
v_sub_f32 v217, v217, v198
v_sub_f32 v218, v218, v198
v_sub_f32 v219, v219, v198
v_sub_f32 v228, v228, v198
v_sub_f32 v229, v229, v198
v_sub_f32 v230, v230, v198
v_sub_f32 v231, v231, v198
v_mul_f32 v234, v201, v234
L_fixo:
v_accvgpr_read_b32 v204, a0
v_accvgpr_read_b32 v205, a1
v_accvgpr_read_b32 v206, a2
v_accvgpr_read_b32 v207, a3
v_mul_f32 v204, v199, v204
v_mul_f32 v205, v199, v205
v_mul_f32 v206, v199, v206
v_mul_f32 v207, v199, v207
v_accvgpr_write_b32 a0, v204
v_accvgpr_write_b32 a1, v205
v_accvgpr_write_b32 a2, v206
v_accvgpr_write_b32 a3, v207
v_accvgpr_read_b32 v204, a4
v_accvgpr_read_b32 v205, a5
v_accvgpr_read_b32 v206, a6
v_accvgpr_read_b32 v207, a7
v_mul_f32 v204, v200, v204
v_mul_f32 v205, v200, v205
v_mul_f32 v206, v200, v206
v_mul_f32 v207, v200, v207
v_accvgpr_write_b32 a4, v204
v_accvgpr_write_b32 a5, v205
v_accvgpr_write_b32 a6, v206
v_accvgpr_write_b32 a7, v207
v_accvgpr_read_b32 v204, a8
v_accvgpr_read_b32 v205, a9
v_accvgpr_read_b32 v206, a10
v_accvgpr_read_b32 v207, a11
v_mul_f32 v204, v201, v204
v_mul_f32 v205, v201, v205
v_mul_f32 v206, v201, v206
v_mul_f32 v207, v201, v207
v_accvgpr_write_b32 a8, v204
v_accvgpr_write_b32 a9, v205
v_accvgpr_write_b32 a10, v206
v_accvgpr_write_b32 a11, v207
v_accvgpr_read_b32 v204, a12
v_accvgpr_read_b32 v205, a13
v_accvgpr_read_b32 v206, a14
v_accvgpr_read_b32 v207, a15
v_mul_f32 v204, v199, v204
v_mul_f32 v205, v199, v205
v_mul_f32 v206, v199, v206
v_mul_f32 v207, v199, v207
v_accvgpr_write_b32 a12, v204
v_accvgpr_write_b32 a13, v205
v_accvgpr_write_b32 a14, v206
v_accvgpr_write_b32 a15, v207
v_accvgpr_read_b32 v204, a16
v_accvgpr_read_b32 v205, a17
v_accvgpr_read_b32 v206, a18
v_accvgpr_read_b32 v207, a19
v_mul_f32 v204, v200, v204
v_mul_f32 v205, v200, v205
v_mul_f32 v206, v200, v206
v_mul_f32 v207, v200, v207
v_accvgpr_write_b32 a16, v204
v_accvgpr_write_b32 a17, v205
v_accvgpr_write_b32 a18, v206
v_accvgpr_write_b32 a19, v207
v_accvgpr_read_b32 v204, a20
v_accvgpr_read_b32 v205, a21
v_accvgpr_read_b32 v206, a22
v_accvgpr_read_b32 v207, a23
v_mul_f32 v204, v201, v204
v_mul_f32 v205, v201, v205
v_mul_f32 v206, v201, v206
v_mul_f32 v207, v201, v207
v_accvgpr_write_b32 a20, v204
v_accvgpr_write_b32 a21, v205
v_accvgpr_write_b32 a22, v206
v_accvgpr_write_b32 a23, v207
v_accvgpr_read_b32 v204, a24
v_accvgpr_read_b32 v205, a25
v_accvgpr_read_b32 v206, a26
v_accvgpr_read_b32 v207, a27
v_mul_f32 v204, v199, v204
v_mul_f32 v205, v199, v205
v_mul_f32 v206, v199, v206
v_mul_f32 v207, v199, v207
v_accvgpr_write_b32 a24, v204
v_accvgpr_write_b32 a25, v205
v_accvgpr_write_b32 a26, v206
v_accvgpr_write_b32 a27, v207
v_accvgpr_read_b32 v204, a28
v_accvgpr_read_b32 v205, a29
v_accvgpr_read_b32 v206, a30
v_accvgpr_read_b32 v207, a31
v_mul_f32 v204, v200, v204
v_mul_f32 v205, v200, v205
v_mul_f32 v206, v200, v206
v_mul_f32 v207, v200, v207
v_accvgpr_write_b32 a28, v204
v_accvgpr_write_b32 a29, v205
v_accvgpr_write_b32 a30, v206
v_accvgpr_write_b32 a31, v207
v_accvgpr_read_b32 v204, a32
v_accvgpr_read_b32 v205, a33
v_accvgpr_read_b32 v206, a34
v_accvgpr_read_b32 v207, a35
v_mul_f32 v204, v201, v204
v_mul_f32 v205, v201, v205
v_mul_f32 v206, v201, v206
v_mul_f32 v207, v201, v207
v_accvgpr_write_b32 a32, v204
v_accvgpr_write_b32 a33, v205
v_accvgpr_write_b32 a34, v206
v_accvgpr_write_b32 a35, v207
v_accvgpr_read_b32 v204, a36
v_accvgpr_read_b32 v205, a37
v_accvgpr_read_b32 v206, a38
v_accvgpr_read_b32 v207, a39
v_mul_f32 v204, v199, v204
v_mul_f32 v205, v199, v205
v_mul_f32 v206, v199, v206
v_mul_f32 v207, v199, v207
v_accvgpr_write_b32 a36, v204
v_accvgpr_write_b32 a37, v205
v_accvgpr_write_b32 a38, v206
v_accvgpr_write_b32 a39, v207
v_accvgpr_read_b32 v204, a40
v_accvgpr_read_b32 v205, a41
v_accvgpr_read_b32 v206, a42
v_accvgpr_read_b32 v207, a43
v_mul_f32 v204, v200, v204
v_mul_f32 v205, v200, v205
v_mul_f32 v206, v200, v206
v_mul_f32 v207, v200, v207
v_accvgpr_write_b32 a40, v204
v_accvgpr_write_b32 a41, v205
v_accvgpr_write_b32 a42, v206
v_accvgpr_write_b32 a43, v207
v_accvgpr_read_b32 v204, a44
v_accvgpr_read_b32 v205, a45
v_accvgpr_read_b32 v206, a46
v_accvgpr_read_b32 v207, a47
v_mul_f32 v204, v201, v204
v_mul_f32 v205, v201, v205
v_mul_f32 v206, v201, v206
v_mul_f32 v207, v201, v207
v_accvgpr_write_b32 a44, v204
v_accvgpr_write_b32 a45, v205
v_accvgpr_write_b32 a46, v206
v_accvgpr_write_b32 a47, v207
v_accvgpr_read_b32 v204, a48
v_accvgpr_read_b32 v205, a49
v_accvgpr_read_b32 v206, a50
v_accvgpr_read_b32 v207, a51
v_mul_f32 v204, v199, v204
v_mul_f32 v205, v199, v205
v_mul_f32 v206, v199, v206
v_mul_f32 v207, v199, v207
v_accvgpr_write_b32 a48, v204
v_accvgpr_write_b32 a49, v205
v_accvgpr_write_b32 a50, v206
v_accvgpr_write_b32 a51, v207
v_accvgpr_read_b32 v204, a52
v_accvgpr_read_b32 v205, a53
v_accvgpr_read_b32 v206, a54
v_accvgpr_read_b32 v207, a55
v_mul_f32 v204, v200, v204
v_mul_f32 v205, v200, v205
v_mul_f32 v206, v200, v206
v_mul_f32 v207, v200, v207
v_accvgpr_write_b32 a52, v204
v_accvgpr_write_b32 a53, v205
v_accvgpr_write_b32 a54, v206
v_accvgpr_write_b32 a55, v207
v_accvgpr_read_b32 v204, a56
v_accvgpr_read_b32 v205, a57
v_accvgpr_read_b32 v206, a58
v_accvgpr_read_b32 v207, a59
v_mul_f32 v204, v201, v204
v_mul_f32 v205, v201, v205
v_mul_f32 v206, v201, v206
v_mul_f32 v207, v201, v207
v_accvgpr_write_b32 a56, v204
v_accvgpr_write_b32 a57, v205
v_accvgpr_write_b32 a58, v206
v_accvgpr_write_b32 a59, v207
v_accvgpr_read_b32 v204, a60
v_accvgpr_read_b32 v205, a61
v_accvgpr_read_b32 v206, a62
v_accvgpr_read_b32 v207, a63
v_mul_f32 v204, v199, v204
v_mul_f32 v205, v199, v205
v_mul_f32 v206, v199, v206
v_mul_f32 v207, v199, v207
v_accvgpr_write_b32 a60, v204
v_accvgpr_write_b32 a61, v205
v_accvgpr_write_b32 a62, v206
v_accvgpr_write_b32 a63, v207
v_accvgpr_read_b32 v204, a64
v_accvgpr_read_b32 v205, a65
v_accvgpr_read_b32 v206, a66
v_accvgpr_read_b32 v207, a67
v_mul_f32 v204, v200, v204
v_mul_f32 v205, v200, v205
v_mul_f32 v206, v200, v206
v_mul_f32 v207, v200, v207
v_accvgpr_write_b32 a64, v204
v_accvgpr_write_b32 a65, v205
v_accvgpr_write_b32 a66, v206
v_accvgpr_write_b32 a67, v207
v_accvgpr_read_b32 v204, a68
v_accvgpr_read_b32 v205, a69
v_accvgpr_read_b32 v206, a70
v_accvgpr_read_b32 v207, a71
v_mul_f32 v204, v201, v204
v_mul_f32 v205, v201, v205
v_mul_f32 v206, v201, v206
v_mul_f32 v207, v201, v207
v_accvgpr_write_b32 a68, v204
v_accvgpr_write_b32 a69, v205
v_accvgpr_write_b32 a70, v206
v_accvgpr_write_b32 a71, v207
v_accvgpr_read_b32 v204, a72
v_accvgpr_read_b32 v205, a73
v_accvgpr_read_b32 v206, a74
v_accvgpr_read_b32 v207, a75
v_mul_f32 v204, v199, v204
v_mul_f32 v205, v199, v205
v_mul_f32 v206, v199, v206
v_mul_f32 v207, v199, v207
v_accvgpr_write_b32 a72, v204
v_accvgpr_write_b32 a73, v205
v_accvgpr_write_b32 a74, v206
v_accvgpr_write_b32 a75, v207
v_accvgpr_read_b32 v204, a76
v_accvgpr_read_b32 v205, a77
v_accvgpr_read_b32 v206, a78
v_accvgpr_read_b32 v207, a79
v_mul_f32 v204, v200, v204
v_mul_f32 v205, v200, v205
v_mul_f32 v206, v200, v206
v_mul_f32 v207, v200, v207
v_accvgpr_write_b32 a76, v204
v_accvgpr_write_b32 a77, v205
v_accvgpr_write_b32 a78, v206
v_accvgpr_write_b32 a79, v207
v_accvgpr_read_b32 v204, a80
v_accvgpr_read_b32 v205, a81
v_accvgpr_read_b32 v206, a82
v_accvgpr_read_b32 v207, a83
v_mul_f32 v204, v201, v204
v_mul_f32 v205, v201, v205
v_mul_f32 v206, v201, v206
v_mul_f32 v207, v201, v207
v_accvgpr_write_b32 a80, v204
v_accvgpr_write_b32 a81, v205
v_accvgpr_write_b32 a82, v206
v_accvgpr_write_b32 a83, v207
v_accvgpr_read_b32 v204, a84
v_accvgpr_read_b32 v205, a85
v_accvgpr_read_b32 v206, a86
v_accvgpr_read_b32 v207, a87
v_mul_f32 v204, v199, v204
v_mul_f32 v205, v199, v205
v_mul_f32 v206, v199, v206
v_mul_f32 v207, v199, v207
v_accvgpr_write_b32 a84, v204
v_accvgpr_write_b32 a85, v205
v_accvgpr_write_b32 a86, v206
v_accvgpr_write_b32 a87, v207
v_accvgpr_read_b32 v204, a88
v_accvgpr_read_b32 v205, a89
v_accvgpr_read_b32 v206, a90
v_accvgpr_read_b32 v207, a91
v_mul_f32 v204, v200, v204
v_mul_f32 v205, v200, v205
v_mul_f32 v206, v200, v206
v_mul_f32 v207, v200, v207
v_accvgpr_write_b32 a88, v204
v_accvgpr_write_b32 a89, v205
v_accvgpr_write_b32 a90, v206
v_accvgpr_write_b32 a91, v207
v_accvgpr_read_b32 v204, a92
v_accvgpr_read_b32 v205, a93
v_accvgpr_read_b32 v206, a94
v_accvgpr_read_b32 v207, a95
v_mul_f32 v204, v201, v204
v_mul_f32 v205, v201, v205
v_mul_f32 v206, v201, v206
v_mul_f32 v207, v201, v207
v_accvgpr_write_b32 a92, v204
v_accvgpr_write_b32 a93, v205
v_accvgpr_write_b32 a94, v206
v_accvgpr_write_b32 a95, v207
v_accvgpr_read_b32 v204, a96
v_accvgpr_read_b32 v205, a97
v_accvgpr_read_b32 v206, a98
v_accvgpr_read_b32 v207, a99
v_mul_f32 v204, v199, v204
v_mul_f32 v205, v199, v205
v_mul_f32 v206, v199, v206
v_mul_f32 v207, v199, v207
v_accvgpr_write_b32 a96, v204
v_accvgpr_write_b32 a97, v205
v_accvgpr_write_b32 a98, v206
v_accvgpr_write_b32 a99, v207
v_accvgpr_read_b32 v204, a100
v_accvgpr_read_b32 v205, a101
v_accvgpr_read_b32 v206, a102
v_accvgpr_read_b32 v207, a103
v_mul_f32 v204, v200, v204
v_mul_f32 v205, v200, v205
v_mul_f32 v206, v200, v206
v_mul_f32 v207, v200, v207
v_accvgpr_write_b32 a100, v204
v_accvgpr_write_b32 a101, v205
v_accvgpr_write_b32 a102, v206
v_accvgpr_write_b32 a103, v207
v_accvgpr_read_b32 v204, a104
v_accvgpr_read_b32 v205, a105
v_accvgpr_read_b32 v206, a106
v_accvgpr_read_b32 v207, a107
v_mul_f32 v204, v201, v204
v_mul_f32 v205, v201, v205
v_mul_f32 v206, v201, v206
v_mul_f32 v207, v201, v207
v_accvgpr_write_b32 a104, v204
v_accvgpr_write_b32 a105, v205
v_accvgpr_write_b32 a106, v206
v_accvgpr_write_b32 a107, v207
v_accvgpr_read_b32 v204, a108
v_accvgpr_read_b32 v205, a109
v_accvgpr_read_b32 v206, a110
v_accvgpr_read_b32 v207, a111
v_mul_f32 v204, v199, v204
v_mul_f32 v205, v199, v205
v_mul_f32 v206, v199, v206
v_mul_f32 v207, v199, v207
v_accvgpr_write_b32 a108, v204
v_accvgpr_write_b32 a109, v205
v_accvgpr_write_b32 a110, v206
v_accvgpr_write_b32 a111, v207
v_accvgpr_read_b32 v204, a112
v_accvgpr_read_b32 v205, a113
v_accvgpr_read_b32 v206, a114
v_accvgpr_read_b32 v207, a115
v_mul_f32 v204, v200, v204
v_mul_f32 v205, v200, v205
v_mul_f32 v206, v200, v206
v_mul_f32 v207, v200, v207
v_accvgpr_write_b32 a112, v204
v_accvgpr_write_b32 a113, v205
v_accvgpr_write_b32 a114, v206
v_accvgpr_write_b32 a115, v207
v_accvgpr_read_b32 v204, a116
v_accvgpr_read_b32 v205, a117
v_accvgpr_read_b32 v206, a118
v_accvgpr_read_b32 v207, a119
v_mul_f32 v204, v201, v204
v_mul_f32 v205, v201, v205
v_mul_f32 v206, v201, v206
v_mul_f32 v207, v201, v207
v_accvgpr_write_b32 a116, v204
v_accvgpr_write_b32 a117, v205
v_accvgpr_write_b32 a118, v206
v_accvgpr_write_b32 a119, v207
v_accvgpr_read_b32 v204, a120
v_accvgpr_read_b32 v205, a121
v_accvgpr_read_b32 v206, a122
v_accvgpr_read_b32 v207, a123
v_mul_f32 v204, v199, v204
v_mul_f32 v205, v199, v205
v_mul_f32 v206, v199, v206
v_mul_f32 v207, v199, v207
v_accvgpr_write_b32 a120, v204
v_accvgpr_write_b32 a121, v205
v_accvgpr_write_b32 a122, v206
v_accvgpr_write_b32 a123, v207
v_accvgpr_read_b32 v204, a124
v_accvgpr_read_b32 v205, a125
v_accvgpr_read_b32 v206, a126
v_accvgpr_read_b32 v207, a127
v_mul_f32 v204, v200, v204
v_mul_f32 v205, v200, v205
v_mul_f32 v206, v200, v206
v_mul_f32 v207, v200, v207
v_accvgpr_write_b32 a124, v204
v_accvgpr_write_b32 a125, v205
v_accvgpr_write_b32 a126, v206
v_accvgpr_write_b32 a127, v207
v_accvgpr_read_b32 v204, a128
v_accvgpr_read_b32 v205, a129
v_accvgpr_read_b32 v206, a130
v_accvgpr_read_b32 v207, a131
v_mul_f32 v204, v201, v204
v_mul_f32 v205, v201, v205
v_mul_f32 v206, v201, v206
v_mul_f32 v207, v201, v207
v_accvgpr_write_b32 a128, v204
v_accvgpr_write_b32 a129, v205
v_accvgpr_write_b32 a130, v206
v_accvgpr_write_b32 a131, v207
v_accvgpr_read_b32 v204, a132
v_accvgpr_read_b32 v205, a133
v_accvgpr_read_b32 v206, a134
v_accvgpr_read_b32 v207, a135
v_mul_f32 v204, v199, v204
v_mul_f32 v205, v199, v205
v_mul_f32 v206, v199, v206
v_mul_f32 v207, v199, v207
v_accvgpr_write_b32 a132, v204
v_accvgpr_write_b32 a133, v205
v_accvgpr_write_b32 a134, v206
v_accvgpr_write_b32 a135, v207
v_accvgpr_read_b32 v204, a136
v_accvgpr_read_b32 v205, a137
v_accvgpr_read_b32 v206, a138
v_accvgpr_read_b32 v207, a139
v_mul_f32 v204, v200, v204
v_mul_f32 v205, v200, v205
v_mul_f32 v206, v200, v206
v_mul_f32 v207, v200, v207
v_accvgpr_write_b32 a136, v204
v_accvgpr_write_b32 a137, v205
v_accvgpr_write_b32 a138, v206
v_accvgpr_write_b32 a139, v207
v_accvgpr_read_b32 v204, a140
v_accvgpr_read_b32 v205, a141
v_accvgpr_read_b32 v206, a142
v_accvgpr_read_b32 v207, a143
v_mul_f32 v204, v201, v204
v_mul_f32 v205, v201, v205
v_mul_f32 v206, v201, v206
v_mul_f32 v207, v201, v207
v_accvgpr_write_b32 a140, v204
v_accvgpr_write_b32 a141, v205
v_accvgpr_write_b32 a142, v206
v_accvgpr_write_b32 a143, v207
v_accvgpr_read_b32 v204, a144
v_accvgpr_read_b32 v205, a145
v_accvgpr_read_b32 v206, a146
v_accvgpr_read_b32 v207, a147
v_mul_f32 v204, v199, v204
v_mul_f32 v205, v199, v205
v_mul_f32 v206, v199, v206
v_mul_f32 v207, v199, v207
v_accvgpr_write_b32 a144, v204
v_accvgpr_write_b32 a145, v205
v_accvgpr_write_b32 a146, v206
v_accvgpr_write_b32 a147, v207
v_accvgpr_read_b32 v204, a148
v_accvgpr_read_b32 v205, a149
v_accvgpr_read_b32 v206, a150
v_accvgpr_read_b32 v207, a151
v_mul_f32 v204, v200, v204
v_mul_f32 v205, v200, v205
v_mul_f32 v206, v200, v206
v_mul_f32 v207, v200, v207
v_accvgpr_write_b32 a148, v204
v_accvgpr_write_b32 a149, v205
v_accvgpr_write_b32 a150, v206
v_accvgpr_write_b32 a151, v207
v_accvgpr_read_b32 v204, a152
v_accvgpr_read_b32 v205, a153
v_accvgpr_read_b32 v206, a154
v_accvgpr_read_b32 v207, a155
v_mul_f32 v204, v201, v204
v_mul_f32 v205, v201, v205
v_mul_f32 v206, v201, v206
v_mul_f32 v207, v201, v207
v_accvgpr_write_b32 a152, v204
v_accvgpr_write_b32 a153, v205
v_accvgpr_write_b32 a154, v206
v_accvgpr_write_b32 a155, v207
v_accvgpr_read_b32 v204, a156
v_accvgpr_read_b32 v205, a157
v_accvgpr_read_b32 v206, a158
v_accvgpr_read_b32 v207, a159
v_mul_f32 v204, v199, v204
v_mul_f32 v205, v199, v205
v_mul_f32 v206, v199, v206
v_mul_f32 v207, v199, v207
v_accvgpr_write_b32 a156, v204
v_accvgpr_write_b32 a157, v205
v_accvgpr_write_b32 a158, v206
v_accvgpr_write_b32 a159, v207
v_accvgpr_read_b32 v204, a160
v_accvgpr_read_b32 v205, a161
v_accvgpr_read_b32 v206, a162
v_accvgpr_read_b32 v207, a163
v_mul_f32 v204, v200, v204
v_mul_f32 v205, v200, v205
v_mul_f32 v206, v200, v206
v_mul_f32 v207, v200, v207
v_accvgpr_write_b32 a160, v204
v_accvgpr_write_b32 a161, v205
v_accvgpr_write_b32 a162, v206
v_accvgpr_write_b32 a163, v207
v_accvgpr_read_b32 v204, a164
v_accvgpr_read_b32 v205, a165
v_accvgpr_read_b32 v206, a166
v_accvgpr_read_b32 v207, a167
v_mul_f32 v204, v201, v204
v_mul_f32 v205, v201, v205
v_mul_f32 v206, v201, v206
v_mul_f32 v207, v201, v207
v_accvgpr_write_b32 a164, v204
v_accvgpr_write_b32 a165, v205
v_accvgpr_write_b32 a166, v206
v_accvgpr_write_b32 a167, v207
v_accvgpr_read_b32 v204, a168
v_accvgpr_read_b32 v205, a169
v_accvgpr_read_b32 v206, a170
v_accvgpr_read_b32 v207, a171
v_mul_f32 v204, v199, v204
v_mul_f32 v205, v199, v205
v_mul_f32 v206, v199, v206
v_mul_f32 v207, v199, v207
v_accvgpr_write_b32 a168, v204
v_accvgpr_write_b32 a169, v205
v_accvgpr_write_b32 a170, v206
v_accvgpr_write_b32 a171, v207
v_accvgpr_read_b32 v204, a172
v_accvgpr_read_b32 v205, a173
v_accvgpr_read_b32 v206, a174
v_accvgpr_read_b32 v207, a175
v_mul_f32 v204, v200, v204
v_mul_f32 v205, v200, v205
v_mul_f32 v206, v200, v206
v_mul_f32 v207, v200, v207
v_accvgpr_write_b32 a172, v204
v_accvgpr_write_b32 a173, v205
v_accvgpr_write_b32 a174, v206
v_accvgpr_write_b32 a175, v207
v_accvgpr_read_b32 v204, a176
v_accvgpr_read_b32 v205, a177
v_accvgpr_read_b32 v206, a178
v_accvgpr_read_b32 v207, a179
v_mul_f32 v204, v201, v204
v_mul_f32 v205, v201, v205
v_mul_f32 v206, v201, v206
v_mul_f32 v207, v201, v207
v_accvgpr_write_b32 a176, v204
v_accvgpr_write_b32 a177, v205
v_accvgpr_write_b32 a178, v206
v_accvgpr_write_b32 a179, v207
v_accvgpr_read_b32 v204, a180
v_accvgpr_read_b32 v205, a181
v_accvgpr_read_b32 v206, a182
v_accvgpr_read_b32 v207, a183
v_mul_f32 v204, v199, v204
v_mul_f32 v205, v199, v205
v_mul_f32 v206, v199, v206
v_mul_f32 v207, v199, v207
v_accvgpr_write_b32 a180, v204
v_accvgpr_write_b32 a181, v205
v_accvgpr_write_b32 a182, v206
v_accvgpr_write_b32 a183, v207
v_accvgpr_read_b32 v204, a184
v_accvgpr_read_b32 v205, a185
v_accvgpr_read_b32 v206, a186
v_accvgpr_read_b32 v207, a187
v_mul_f32 v204, v200, v204
v_mul_f32 v205, v200, v205
v_mul_f32 v206, v200, v206
v_mul_f32 v207, v200, v207
v_accvgpr_write_b32 a184, v204
v_accvgpr_write_b32 a185, v205
v_accvgpr_write_b32 a186, v206
v_accvgpr_write_b32 a187, v207
v_accvgpr_read_b32 v204, a188
v_accvgpr_read_b32 v205, a189
v_accvgpr_read_b32 v206, a190
v_accvgpr_read_b32 v207, a191
v_mul_f32 v204, v201, v204
v_mul_f32 v205, v201, v205
v_mul_f32 v206, v201, v206
v_mul_f32 v207, v201, v207
v_accvgpr_write_b32 a188, v204
v_accvgpr_write_b32 a189, v205
v_accvgpr_write_b32 a190, v206
v_accvgpr_write_b32 a191, v207
s_setpc_b64 s[74:75]
L_code_end:
.section .rodata,"a"
.p2align 6
.amdhsa_kernel concat_heads__gqa_block_cached__mha_block_cached__near_ridge_kernel
  .amdhsa_next_free_vgpr 512
  .amdhsa_next_free_sgpr 102
  .amdhsa_accum_offset 256
  .amdhsa_group_segment_fixed_size 0
  .amdhsa_kernarg_size 104
  .amdhsa_user_sgpr_count 2
  .amdhsa_user_sgpr_kernarg_segment_ptr 1
  .amdhsa_system_sgpr_workgroup_id_x 1
.end_amdhsa_kernel
```
